```python
import torch

def _softmax(x, axis=-1):
    return torch.softmax(x, dim=axis)
def _gelu(x):
    return torch.nn.functional.gelu(x, approximate="tanh")
def _silu(x):
    return torch.nn.functional.silu(x)
def _sigmoid(x):
    return torch.sigmoid(x)
def _layernorm(x, axis=-1, eps=1e-5):
    m = x.mean(dim=axis, keepdim=True)
    v = x.var(dim=axis, keepdim=True, unbiased=False)
    return (x - m) / torch.sqrt(v + eps)
def _scatter_add(tgt, idx, src, axis=0):
    return tgt.clone().index_add_(axis, idx, src)
def _segment_sum(src, seg, n):
    out = torch.zeros((n,) + src.shape[1:], dtype=src.dtype)
    return out.index_add_(0, seg, src)
def _pad(x, pw):
    flat = tuple(v for pair in reversed(pw) for v in pair)
    return torch.nn.functional.pad(x, flat)

kernel_name = 'gated_mix__mha_block__glu_gated_reglu__prompt'

def setup_inputs():

    _w = (lambda a: (lambda t: t.to(torch.bfloat16) if t.is_floating_point() else t)(torch.as_tensor(a)))
    def _A_setup():
        B, S, D, H = 1, 2048, 512, 32
        return {
            "x": _w((lambda *s: torch.randn(*s, dtype=torch.bfloat16) * 0.05)(B, S, D)),
            "wqkv": _w((lambda *s: torch.randn(*s, dtype=torch.bfloat16) * 0.8)(D, 3 * D)),
            "wo": _w((lambda *s: torch.randn(*s, dtype=torch.bfloat16) * 0.05)(D, D)),
        }
    _A_in = _A_setup()

    def _B_setup():
        B, S, D, F = 1, 2048, 512, 1792
        return {
            "x": _w((lambda *s: torch.randn(*s, dtype=torch.bfloat16) * 0.05)(B, S, D)),
            "W_gate": _w((lambda *s: torch.randn(*s, dtype=torch.bfloat16) * 1.6)(D, F) * (2.0 / D) ** 0.5),
            "W_up": _w((lambda *s: torch.randn(*s, dtype=torch.bfloat16) * 1.6)(D, F) * (2.0 / D) ** 0.5),
            "W_down": _w((lambda *s: torch.randn(*s, dtype=torch.bfloat16) * 1.6)(F, D) * (1.0 / F) ** 0.5),
        }
    _B_in = _B_setup()

    return {
        "A_x": _A_in["x"],
        "A_wqkv": _A_in["wqkv"],
        "A_wo": _A_in["wo"],
        "B_x": _B_in["x"],
        "B_W_gate": _B_in["W_gate"],
        "B_W_up": _B_in["W_up"],
        "B_W_down": _B_in["W_down"],
        "gate_w": _w((lambda *s: torch.randn(*s, dtype=torch.bfloat16) * 0.05)(512) * 16.0),
    }

def reference(A_x, A_wqkv, A_wo, B_x, B_W_gate, B_W_up, B_W_down, gate_w):
    def _A_ref(x, wqkv, wo):
        B, S, D = x.shape
        H = 32
        Dh = D // H
        qkv = (lambda x, *d: x.permute(*d))((x @ wqkv).reshape(B, S, 3, H, Dh), 2, 0, 3, 1, 4)
        q, k, v = qkv[0], qkv[1], qkv[2]
        scores = torch.einsum("bhqd,bhkd->bhqk", q, k) * (Dh ** -0.5)
        p = _softmax(scores, axis=-1)
        o = torch.einsum("bhqk,bhkd->bhqd", p, v)
        return (lambda x, *d: x.permute(*d))(o, 0, 2, 1, 3).reshape(B, S, D) @ wo

    def _B_ref(x, W_gate, W_up, W_down):
        gate = torch.einsum("bsd,df->bsf", x, W_gate)
        up = torch.einsum("bsd,df->bsf", x, W_up)
        gate = gate * (lambda x, dt: x.to(dt))(gate > 0, gate.dtype)
        h = gate * up
        return torch.einsum("bsf,fd->bsd", h, W_down)

    x = A_x
    g = _sigmoid((x * gate_w).sum(-1, keepdims=True))
    a = _A_ref(x, A_wqkv, A_wo)
    b = _B_ref(x, B_W_gate, B_W_up, B_W_down)
    return g * a + (1 - g) * b
```

```asm
; @launch grid=(256,1,1) block=(512,1,1) lds=163840
.amdgcn_target "amdgcn-amd-amdhsa--gfx950"
.text
.globl gated_mix__mha_block__glu_gated_reglu__prompt_kernel
.p2align 8
.type gated_mix__mha_block__glu_gated_reglu__prompt_kernel,@function
gated_mix__mha_block__glu_gated_reglu__prompt_kernel:
    s_cmp_ge_u32 s2, 256
    s_cbranch_scc1 L_end
    s_load_dwordx4 s[4:7], s[0:1], 0
    s_load_dwordx2 s[8:9], s[0:1], 16
    s_load_dwordx4 s[12:15], s[0:1], 32
    s_load_dwordx4 s[16:19], s[0:1], 48
    s_load_dwordx4 s[20:23], s[0:1], 64
    s_load_dwordx2 s[24:25], s[0:1], 80
    s_getpc_b64 s[26:27]
L_pfbase:
    s_lshr_b32 s3, s2, 3
    v_lshrrev_b32 v1, 6, v0
    v_lshl_add_u32 v1, s3, 3, v1
    v_and_b32 v2, 3, v0
    v_lshl_add_u32 v1, v1, 2, v2
    v_min_u32 v1, (L_codeend-L_pfbase)/64-1, v1
    v_lshlrev_b32 v1, 6, v1
    global_load_dword v127, v1, s[26:27]
    v_lshrrev_b32 v1, 6, v0
    v_and_b32 v2, 63, v0
    v_readfirstlane_b32 s48, v1
    s_and_b32 s54, s2, 7
    s_lshr_b32 s55, s2, 3
    s_and_b32 s49, s55, 15
    s_lshr_b32 s67, s55, 4
    s_mov_b32 s50, s54
    s_and_b32 s51, s48, 3
    s_lshr_b32 s52, s48, 2
    s_lshl_b32 s56, s49, 2
    s_add_u32 s53, s56, s51
    s_lshl_b32 s56, s54, 2
    s_and_b32 s57, s55, 3
    s_add_u32 s63, s56, s57
    s_lshr_b32 s64, s55, 2
    s_mov_b32 s65, 0x3eb8aa3b
    v_lshlrev_b32 v13, 4, v2
    s_lshl_b32 s56, s49, 7
    s_lshl_b32 s57, s48, 4
    s_add_u32 s56, s56, s57
    v_lshrrev_b32 v49, 3, v2
    v_add_u32 v50, s56, v49
    v_lshrrev_b32 v48, 4, v2
    v_and_b32 v51, 7, v2
    v_xor_b32 v48, v48, v51
    v_lshlrev_b32 v48, 4, v48
    v_lshl_add_u32 v3, v50, 10, v48
    v_xor_b32 v48, 64, v3
    v_add_u32 v4, 8192, v48
    v_bfe_u32 v48, v2, 4, 1
    v_lshlrev_b32 v48, 2, v48
    v_xor_b32 v51, v51, v48
    v_lshlrev_b32 v51, 4, v51
    s_lshl_b32 s56, s48, 3
    v_add_u32 v49, s56, v49
    s_mul_i32 s56, s50, 320
    s_add_u32 s56, s56, 1024
    s_and_b32 s57, s50, 1
    s_mul_i32 s58, s57, 192
    s_add_u32 s27, s56, s58
    s_xor_b32 s57, s57, 1
    s_lshl_b32 s57, s57, 7
    s_add_u32 s60, s56, s57
    s_lshl_b32 s56, s50, 7
    s_cmp_eq_u32 s67, 0
    s_cselect_b32 s27, s56, s27
    v_mul_u32_u24 v48, 3584, v49
    v_add3_u32 v8, v48, v51, s27
    v_xor_b32 v50, 32, v51
    v_add3_u32 v9, v48, v50, s27
    s_cbranch_scc0 L_setupB
    v_mul_u32_u24 v48, 3072, v49
    v_add3_u32 v5, v48, v51, s56
    v_add3_u32 v50, v48, v50, s56
    v_add_u32 v6, 1024, v50
    v_add_u32 v7, 2048, v5
    s_lshl_b32 s11, s48, 10
    s_add_u32 s11, s11, 16384
    s_movk_i32 s61, 8192
    s_mov_b32 s62, 196608
    s_branch L_setupJ
L_setupB:
    s_and_b32 s56, s48, 3
    s_lshl_b32 s57, s56, 4
    s_mov_b32 s58, 43691
    s_lshl_b32 s59, s52, 1
    v_add_u32 v48, 0, v2
    v_mul_u32_u24 v49, s58, v48
    v_lshrrev_b32 v49, 19, v49
    v_mul_u32_u24 v50, 12, v49
    v_sub_u32 v50, v48, v50
    v_xor_b32 v50, s59, v50
    v_add_u32 v49, s57, v49
    v_mul_u32_u24 v49, 3584, v49
    v_lshl_add_u32 v49, v50, 4, v49
    v_add_u32 v5, s60, v49
    v_add_u32 v48, 64, v2
    v_mul_u32_u24 v49, s58, v48
    v_lshrrev_b32 v49, 19, v49
    v_mul_u32_u24 v50, 12, v49
    v_sub_u32 v50, v48, v50
    v_xor_b32 v50, s59, v50
    v_add_u32 v49, s57, v49
    v_mul_u32_u24 v49, 3584, v49
    v_lshl_add_u32 v49, v50, 4, v49
    v_add_u32 v6, s60, v49
    v_add_u32 v48, 128, v2
    v_mul_u32_u24 v49, s58, v48
    v_lshrrev_b32 v49, 19, v49
    v_mul_u32_u24 v50, 12, v49
    v_sub_u32 v50, v48, v50
    v_xor_b32 v50, s59, v50
    v_add_u32 v49, s57, v49
    v_mul_u32_u24 v49, 3584, v49
    v_lshl_add_u32 v49, v50, 4, v49
    v_add_u32 v7, s60, v49
    s_mul_i32 s11, s56, 3072
    s_mul_i32 s57, s52, 12288
    s_add_u32 s11, s11, s57
    s_add_u32 s11, s11, 16384
    s_movk_i32 s61, 1024
    s_mov_b32 s62, 229376
    s_lshr_b32 s68, s60, 5
L_setupJ:
    s_lshl_b32 s10, s48, 11
    s_lshl_b32 s3, s48, 12
    s_lshl_b32 s26, s48, 10
    s_mov_b32 s100, 0
    s_waitcnt lgkmcnt(0)
    s_mov_b32 s28, s4
    s_mov_b32 s29, s5
    s_mov_b32 s30, 0x200000
    s_mov_b32 s31, 0x20000
    s_add_u32 s0, s11, s61
    s_add_u32 s1, s0, s61
    s_cmp_eq_u32 s52, 0
    s_cselect_b32 s96, s12, s14
    s_cselect_b32 s97, s13, s15
    s_mov_b32 s98, 0x1c0000
    s_cmp_eq_u32 s67, 0
    s_cselect_b32 s96, s6, s96
    s_cselect_b32 s97, s7, s97
    s_cselect_b32 s98, 0x180000, s98
    s_mov_b32 s99, 0x20000
    s_mov_b32 s32, s24
    s_mov_b32 s33, s25
    s_mov_b32 s34, 0x1100000
    s_mov_b32 s35, 0x20000
    s_add_u32 s56, s2, s48
    s_cmp_eq_u32 s56, 0
    s_cselect_b32 s56, 0, 0x7fff0000
    v_lshlrev_b32 v48, 8, v2
    v_add_u32 v48, s56, v48
    v_mov_b32 v49, 0
    buffer_store_dword v49, v48, s[32:35], 0 offen sc1
    s_add_u32 m0, s10, 0
    s_movk_i32 s57, 0
    buffer_load_dwordx4 v3, s[28:31], s57 offen lds
    s_add_u32 m0, s10, 1024
    s_movk_i32 s57, 0
    buffer_load_dwordx4 v4, s[28:31], s57 offen lds
    s_add_u32 m0, s11, 0
    s_nop 0
    buffer_load_dwordx4 v5, s[96:99], s100 offen lds
    s_add_u32 m0, s0, 0
    s_nop 0
    buffer_load_dwordx4 v6, s[96:99], s100 offen lds
    s_add_u32 m0, s1, 0
    s_nop 0
    buffer_load_dwordx4 v7, s[96:99], s100 offen lds
    s_add_u32 m0, s10, 40960
    s_movk_i32 s57, 128
    buffer_load_dwordx4 v3, s[28:31], s57 offen lds
    s_add_u32 m0, s10, 41984
    s_movk_i32 s57, 128
    buffer_load_dwordx4 v4, s[28:31], s57 offen lds
    s_add_u32 m0, s11, 40960
    s_add_u32 s100, s100, s62
    buffer_load_dwordx4 v5, s[96:99], s100 offen lds
    s_add_u32 m0, s0, 40960
    s_nop 0
    buffer_load_dwordx4 v6, s[96:99], s100 offen lds
    s_add_u32 m0, s1, 40960
    s_nop 0
    buffer_load_dwordx4 v7, s[96:99], s100 offen lds
    s_mov_b32 s40, s22
    s_mov_b32 s41, s23
    s_mov_b32 s42, 0x100
    s_mov_b32 s43, 0x20000
    s_mov_b32 s36, s12
    s_mov_b32 s37, s13
    s_mov_b32 s38, 0x1c0000
    s_mov_b32 s39, 0x20000
    s_mov_b32 s4, s14
    s_mov_b32 s5, s15
    s_mov_b32 s6, 0x1c0000
    s_mov_b32 s7, 0x20000
    s_mov_b32 s44, s18
    s_mov_b32 s45, s19
    s_mov_b32 s46, 0x400
    s_mov_b32 s47, 0x20000
    s_lshl_b32 s56, s67, 3
    s_add_u32 s56, s56, s50
    s_lshl_b32 s57, s56, 6
    v_lshrrev_b32 v48, 5, v2
    v_lshlrev_b32 v48, 4, v48
    v_add_u32 v48, s57, v48
    buffer_load_dwordx4 v[112:115], v48, s[44:47], 0 offen
    buffer_load_dwordx4 v[116:119], v48, s[44:47], 0 offen offset:32
    v_lshrrev_b32 v48, 5, v2
    v_lshlrev_b32 v48, 3, v48
    v_bfe_u32 v49, v2, 2, 2
    v_add_u32 v52, v48, v49
    v_and_b32 v48, 1, v2
    v_lshlrev_b32 v48, 4, v48
    v_bfe_u32 v49, v2, 1, 1
    v_lshl_add_u32 v53, v49, 3, v48
    v_bfe_u32 v54, v2, 4, 1
    v_bfe_u32 v48, v2, 3, 1
    v_xor_b32 v48, s52, v48
    v_lshlrev_b32 v48, 6, v48
    v_lshl_add_u32 v48, v52, 7, v48
    v_add_u32 v48, v48, v53
    v_mul_u32_u24 v49, 8224, v54
    v_add_u32 v14, v48, v49
    v_xor_b32 v15, 32, v14
    s_cmp_eq_u32 s67, 0
    s_cbranch_scc0 L_lateB
    v_add_u32 v10, 16384, v14
    v_add_u32 v11, 16384, v15
    v_lshl_add_u32 v49, v54, 5, v48
    v_add_u32 v12, 32768, v49
    s_branch L_lateJ
L_lateB:
    s_mul_i32 s56, s52, 96
    s_add_u32 s56, s56, 16384
    v_mul_u32_u24 v49, 192, v52
    v_add3_u32 v49, v49, v53, s56
    s_lshl_b32 s57, s52, 6
    s_sub_u32 s57, 12320, s57
    s_sub_u32 s58, 24576, s57
    v_mul_u32_u24 v50, s57, v54
    v_add_u32 v10, v49, v50
    v_mul_u32_u24 v50, s58, v54
    v_add_u32 v11, v49, v50
    v_mov_b32 v12, v10
L_lateJ:
    v_and_b32 v48, 31, v2
    s_lshl_b32 s56, s51, 5
    v_add_u32 v49, s56, v48
    v_lshlrev_b32 v49, 7, v49
    v_bfe_u32 v48, v2, 1, 3
    v_lshrrev_b32 v50, 5, v2
    v_xor_b32 v48, v48, v50
    v_lshl_add_u32 v49, v48, 4, v49
    v_xor_b32 v40, 0, v49
    v_xor_b32 v41, 32, v49
    v_xor_b32 v42, 64, v49
    v_xor_b32 v43, 96, v49
    v_mov_b32 v46, 1
    v_mov_b32 v47, 0
    s_waitcnt vmcnt(7)
    s_barrier
    s_cmp_eq_u32 s2, 0
    s_cselect_b32 s56, 0, 0x7fff0000
    v_mov_b32 v48, 0x7fff0000
    v_mov_b32 v49, s56
    v_cmp_eq_u32 vcc, 0, v0
    s_nop 1
    v_cndmask_b32 v48, v48, v49, vcc
    v_mov_b32 v49, 1
    buffer_store_dword v49, v48, s[40:43], 0 offen sc1
    s_cmp_eq_u32 s67, 0
    s_cbranch_scc0 L_p1_B
    ds_read_b128 v[128:131], v40 offset:0
    ds_read_b64_tr_b16 v[16:17], v10 offset:0
    ds_read_b64_tr_b16 v[18:19], v10 offset:512
    ds_read_b64_tr_b16 v[20:21], v11 offset:0
    ds_read_b64_tr_b16 v[22:23], v11 offset:512
    ds_read_b64_tr_b16 v[24:25], v12 offset:0
    ds_read_b64_tr_b16 v[26:27], v12 offset:512
    s_waitcnt lgkmcnt(4)
    v_mfma_f32_32x32x16_bf16 v[64:79], v[16:19], v[128:131], 0
    ds_read_b128 v[132:135], v41 offset:0
    ds_read_b64_tr_b16 v[28:29], v10 offset:2048
    ds_read_b64_tr_b16 v[30:31], v10 offset:2560
    s_add_u32 m0, s10, 81920
    s_movk_i32 s57, 256
    buffer_load_dwordx4 v3, s[28:31], s57 offen lds
    s_waitcnt lgkmcnt(5)
    v_mfma_f32_32x32x16_bf16 v[80:95], v[20:23], v[128:131], 0
    ds_read_b64_tr_b16 v[32:33], v11 offset:2048
    ds_read_b64_tr_b16 v[34:35], v11 offset:2560
    s_add_u32 m0, s10, 82944
    s_movk_i32 s57, 256
    buffer_load_dwordx4 v4, s[28:31], s57 offen lds
    s_waitcnt lgkmcnt(5)
    v_mfma_f32_32x32x16_bf16 v[96:111], v[128:131], v[24:27], 0
    ds_read_b64_tr_b16 v[36:37], v12 offset:2048
    ds_read_b64_tr_b16 v[38:39], v12 offset:2560
    s_waitcnt lgkmcnt(4)
    v_mfma_f32_32x32x16_bf16 v[64:79], v[28:31], v[132:135], v[64:79]
    ds_read_b128 v[136:139], v42 offset:0
    ds_read_b64_tr_b16 v[16:17], v10 offset:4096
    ds_read_b64_tr_b16 v[18:19], v10 offset:4608
    s_add_u32 m0, s11, 81920
    s_add_u32 s100, s100, s62
    buffer_load_dwordx4 v5, s[96:99], s100 offen lds
    s_waitcnt lgkmcnt(5)
    v_mfma_f32_32x32x16_bf16 v[80:95], v[32:35], v[132:135], v[80:95]
    ds_read_b64_tr_b16 v[20:21], v11 offset:4096
    ds_read_b64_tr_b16 v[22:23], v11 offset:4608
    s_add_u32 m0, s0, 81920
    s_nop 0
    buffer_load_dwordx4 v6, s[96:99], s100 offen lds
    s_waitcnt lgkmcnt(5)
    v_mfma_f32_32x32x16_bf16 v[96:111], v[132:135], v[36:39], v[96:111]
    ds_read_b64_tr_b16 v[24:25], v12 offset:4096
    ds_read_b64_tr_b16 v[26:27], v12 offset:4608
    s_waitcnt vmcnt(7)
    s_barrier
    s_waitcnt lgkmcnt(4)
    v_mfma_f32_32x32x16_bf16 v[64:79], v[16:19], v[136:139], v[64:79]
    ds_read_b128 v[140:143], v43 offset:0
    ds_read_b64_tr_b16 v[28:29], v10 offset:6144
    ds_read_b64_tr_b16 v[30:31], v10 offset:6656
    s_add_u32 m0, s1, 81920
    s_nop 0
    buffer_load_dwordx4 v7, s[96:99], s100 offen lds
    s_waitcnt lgkmcnt(5)
    v_mfma_f32_32x32x16_bf16 v[80:95], v[20:23], v[136:139], v[80:95]
    ds_read_b64_tr_b16 v[32:33], v11 offset:6144
    ds_read_b64_tr_b16 v[34:35], v11 offset:6656
    s_add_u32 m0, s10, 122880
    s_movk_i32 s57, 384
    buffer_load_dwordx4 v3, s[28:31], s57 offen lds
    s_waitcnt lgkmcnt(5)
    v_mfma_f32_32x32x16_bf16 v[96:111], v[136:139], v[24:27], v[96:111]
    ds_read_b64_tr_b16 v[36:37], v12 offset:6144
    ds_read_b64_tr_b16 v[38:39], v12 offset:6656
    s_waitcnt lgkmcnt(4)
    v_mfma_f32_32x32x16_bf16 v[64:79], v[28:31], v[140:143], v[64:79]
    ds_read_b128 v[144:147], v40 offset:40960
    ds_read_b64_tr_b16 v[16:17], v10 offset:40960
    ds_read_b64_tr_b16 v[18:19], v10 offset:41472
    s_add_u32 m0, s10, 123904
    s_movk_i32 s57, 384
    buffer_load_dwordx4 v4, s[28:31], s57 offen lds
    s_waitcnt lgkmcnt(5)
    v_mfma_f32_32x32x16_bf16 v[80:95], v[32:35], v[140:143], v[80:95]
    ds_read_b64_tr_b16 v[20:21], v11 offset:40960
    ds_read_b64_tr_b16 v[22:23], v11 offset:41472
    s_add_u32 m0, s11, 122880
    s_add_u32 s100, s100, s62
    buffer_load_dwordx4 v5, s[96:99], s100 offen lds
    s_waitcnt lgkmcnt(5)
    v_mfma_f32_32x32x16_bf16 v[96:111], v[140:143], v[36:39], v[96:111]
    ds_read_b64_tr_b16 v[24:25], v12 offset:40960
    ds_read_b64_tr_b16 v[26:27], v12 offset:41472
    s_waitcnt lgkmcnt(4)
    v_mfma_f32_32x32x16_bf16 v[64:79], v[16:19], v[144:147], v[64:79]
    ds_read_b128 v[148:151], v41 offset:40960
    ds_read_b64_tr_b16 v[28:29], v10 offset:43008
    ds_read_b64_tr_b16 v[30:31], v10 offset:43520
    s_add_u32 m0, s0, 122880
    s_nop 0
    buffer_load_dwordx4 v6, s[96:99], s100 offen lds
    s_waitcnt lgkmcnt(5)
    v_mfma_f32_32x32x16_bf16 v[80:95], v[20:23], v[144:147], v[80:95]
    ds_read_b64_tr_b16 v[32:33], v11 offset:43008
    ds_read_b64_tr_b16 v[34:35], v11 offset:43520
    s_add_u32 m0, s1, 122880
    s_nop 0
    buffer_load_dwordx4 v7, s[96:99], s100 offen lds
    s_waitcnt lgkmcnt(5)
    v_mfma_f32_32x32x16_bf16 v[96:111], v[144:147], v[24:27], v[96:111]
    ds_read_b64_tr_b16 v[36:37], v12 offset:43008
    ds_read_b64_tr_b16 v[38:39], v12 offset:43520
    s_waitcnt lgkmcnt(4)
    v_mfma_f32_32x32x16_bf16 v[64:79], v[28:31], v[148:151], v[64:79]
    ds_read_b128 v[152:155], v42 offset:40960
    ds_read_b64_tr_b16 v[16:17], v10 offset:45056
    ds_read_b64_tr_b16 v[18:19], v10 offset:45568
    s_waitcnt lgkmcnt(5)
    v_mfma_f32_32x32x16_bf16 v[80:95], v[32:35], v[148:151], v[80:95]
    ds_read_b64_tr_b16 v[20:21], v11 offset:45056
    ds_read_b64_tr_b16 v[22:23], v11 offset:45568
    s_waitcnt lgkmcnt(5)
    v_mfma_f32_32x32x16_bf16 v[96:111], v[148:151], v[36:39], v[96:111]
    ds_read_b64_tr_b16 v[24:25], v12 offset:45056
    ds_read_b64_tr_b16 v[26:27], v12 offset:45568
    s_waitcnt vmcnt(5)
    s_barrier
    s_waitcnt lgkmcnt(4)
    v_mfma_f32_32x32x16_bf16 v[64:79], v[16:19], v[152:155], v[64:79]
    ds_read_b128 v[156:159], v43 offset:40960
    ds_read_b64_tr_b16 v[28:29], v10 offset:47104
    ds_read_b64_tr_b16 v[30:31], v10 offset:47616
    s_add_u32 m0, s10, 0
    s_movk_i32 s57, 512
    buffer_load_dwordx4 v3, s[28:31], s57 offen lds
    s_waitcnt lgkmcnt(5)
    v_mfma_f32_32x32x16_bf16 v[80:95], v[20:23], v[152:155], v[80:95]
    ds_read_b64_tr_b16 v[32:33], v11 offset:47104
    ds_read_b64_tr_b16 v[34:35], v11 offset:47616
    s_add_u32 m0, s10, 1024
    s_movk_i32 s57, 512
    buffer_load_dwordx4 v4, s[28:31], s57 offen lds
    s_waitcnt lgkmcnt(5)
    v_mfma_f32_32x32x16_bf16 v[96:111], v[152:155], v[24:27], v[96:111]
    ds_read_b64_tr_b16 v[36:37], v12 offset:47104
    ds_read_b64_tr_b16 v[38:39], v12 offset:47616
    s_waitcnt lgkmcnt(4)
    v_mfma_f32_32x32x16_bf16 v[64:79], v[28:31], v[156:159], v[64:79]
    v_add_u32 v40, 0x14000, v40
    v_add_u32 v41, 0x14000, v41
    v_add_u32 v42, 0x14000, v42
    v_add_u32 v43, 0x14000, v43
    v_add_u32 v10, 0x14000, v10
    v_add_u32 v11, 0x14000, v11
    v_add_u32 v12, 0x14000, v12
    ds_read_b128 v[160:163], v40 offset:0
    ds_read_b64_tr_b16 v[16:17], v10 offset:0
    ds_read_b64_tr_b16 v[18:19], v10 offset:512
    s_add_u32 m0, s11, 0
    s_add_u32 s100, s100, s62
    buffer_load_dwordx4 v5, s[96:99], s100 offen lds
    s_waitcnt lgkmcnt(5)
    v_mfma_f32_32x32x16_bf16 v[80:95], v[32:35], v[156:159], v[80:95]
    ds_read_b64_tr_b16 v[20:21], v11 offset:0
    ds_read_b64_tr_b16 v[22:23], v11 offset:512
    s_add_u32 m0, s0, 0
    s_nop 0
    buffer_load_dwordx4 v6, s[96:99], s100 offen lds
    s_waitcnt lgkmcnt(5)
    v_mfma_f32_32x32x16_bf16 v[96:111], v[156:159], v[36:39], v[96:111]
    ds_read_b64_tr_b16 v[24:25], v12 offset:0
    ds_read_b64_tr_b16 v[26:27], v12 offset:512
    s_waitcnt lgkmcnt(4)
    v_mfma_f32_32x32x16_bf16 v[64:79], v[16:19], v[160:163], v[64:79]
    ds_read_b128 v[164:167], v41 offset:0
    ds_read_b64_tr_b16 v[28:29], v10 offset:2048
    ds_read_b64_tr_b16 v[30:31], v10 offset:2560
    s_add_u32 m0, s1, 0
    s_nop 0
    buffer_load_dwordx4 v7, s[96:99], s100 offen lds
    s_waitcnt lgkmcnt(5)
    v_mfma_f32_32x32x16_bf16 v[80:95], v[20:23], v[160:163], v[80:95]
    ds_read_b64_tr_b16 v[32:33], v11 offset:2048
    ds_read_b64_tr_b16 v[34:35], v11 offset:2560
    s_waitcnt lgkmcnt(5)
    v_mfma_f32_32x32x16_bf16 v[96:111], v[160:163], v[24:27], v[96:111]
    ds_read_b64_tr_b16 v[36:37], v12 offset:2048
    ds_read_b64_tr_b16 v[38:39], v12 offset:2560
    s_waitcnt lgkmcnt(4)
    v_mfma_f32_32x32x16_bf16 v[64:79], v[28:31], v[164:167], v[64:79]
    ds_read_b128 v[168:171], v42 offset:0
    ds_read_b64_tr_b16 v[16:17], v10 offset:4096
    ds_read_b64_tr_b16 v[18:19], v10 offset:4608
    s_waitcnt lgkmcnt(5)
    v_mfma_f32_32x32x16_bf16 v[80:95], v[32:35], v[164:167], v[80:95]
    ds_read_b64_tr_b16 v[20:21], v11 offset:4096
    ds_read_b64_tr_b16 v[22:23], v11 offset:4608
    s_waitcnt lgkmcnt(5)
    v_mfma_f32_32x32x16_bf16 v[96:111], v[164:167], v[36:39], v[96:111]
    ds_read_b64_tr_b16 v[24:25], v12 offset:4096
    ds_read_b64_tr_b16 v[26:27], v12 offset:4608
    s_waitcnt vmcnt(5)
    s_barrier
    buffer_load_dword v44, v47, s[40:43], 0 offen sc1
    s_waitcnt lgkmcnt(4)
    v_mfma_f32_32x32x16_bf16 v[64:79], v[16:19], v[168:171], v[64:79]
    ds_read_b128 v[172:175], v43 offset:0
    ds_read_b64_tr_b16 v[28:29], v10 offset:6144
    ds_read_b64_tr_b16 v[30:31], v10 offset:6656
    s_add_u32 m0, s10, 40960
    s_movk_i32 s57, 640
    buffer_load_dwordx4 v3, s[28:31], s57 offen lds
    s_waitcnt lgkmcnt(5)
    v_mfma_f32_32x32x16_bf16 v[80:95], v[20:23], v[168:171], v[80:95]
    ds_read_b64_tr_b16 v[32:33], v11 offset:6144
    ds_read_b64_tr_b16 v[34:35], v11 offset:6656
    s_add_u32 m0, s10, 41984
    s_movk_i32 s57, 640
    buffer_load_dwordx4 v4, s[28:31], s57 offen lds
    s_waitcnt lgkmcnt(5)
    v_mfma_f32_32x32x16_bf16 v[96:111], v[168:171], v[24:27], v[96:111]
    ds_read_b64_tr_b16 v[36:37], v12 offset:6144
    ds_read_b64_tr_b16 v[38:39], v12 offset:6656
    s_waitcnt lgkmcnt(4)
    v_mfma_f32_32x32x16_bf16 v[64:79], v[28:31], v[172:175], v[64:79]
    ds_read_b128 v[176:179], v40 offset:40960
    ds_read_b64_tr_b16 v[16:17], v10 offset:40960
    ds_read_b64_tr_b16 v[18:19], v10 offset:41472
    s_add_u32 m0, s11, 40960
    s_add_u32 s100, s100, s62
    buffer_load_dwordx4 v5, s[96:99], s100 offen lds
    s_waitcnt lgkmcnt(5)
    v_mfma_f32_32x32x16_bf16 v[80:95], v[32:35], v[172:175], v[80:95]
    ds_read_b64_tr_b16 v[20:21], v11 offset:40960
    ds_read_b64_tr_b16 v[22:23], v11 offset:41472
    s_add_u32 m0, s0, 40960
    s_nop 0
    buffer_load_dwordx4 v6, s[96:99], s100 offen lds
    s_waitcnt lgkmcnt(5)
    v_mfma_f32_32x32x16_bf16 v[96:111], v[172:175], v[36:39], v[96:111]
    ds_read_b64_tr_b16 v[24:25], v12 offset:40960
    ds_read_b64_tr_b16 v[26:27], v12 offset:41472
    s_waitcnt lgkmcnt(4)
    v_mfma_f32_32x32x16_bf16 v[64:79], v[16:19], v[176:179], v[64:79]
    ds_read_b128 v[180:183], v41 offset:40960
    ds_read_b64_tr_b16 v[28:29], v10 offset:43008
    ds_read_b64_tr_b16 v[30:31], v10 offset:43520
    s_add_u32 m0, s1, 40960
    s_nop 0
    buffer_load_dwordx4 v7, s[96:99], s100 offen lds
    s_waitcnt lgkmcnt(5)
    v_mfma_f32_32x32x16_bf16 v[80:95], v[20:23], v[176:179], v[80:95]
    ds_read_b64_tr_b16 v[32:33], v11 offset:43008
    ds_read_b64_tr_b16 v[34:35], v11 offset:43520
    s_waitcnt lgkmcnt(5)
    v_mfma_f32_32x32x16_bf16 v[96:111], v[176:179], v[24:27], v[96:111]
    ds_read_b64_tr_b16 v[36:37], v12 offset:43008
    ds_read_b64_tr_b16 v[38:39], v12 offset:43520
    s_waitcnt lgkmcnt(4)
    v_mfma_f32_32x32x16_bf16 v[64:79], v[28:31], v[180:183], v[64:79]
    ds_read_b128 v[184:187], v42 offset:40960
    ds_read_b64_tr_b16 v[16:17], v10 offset:45056
    ds_read_b64_tr_b16 v[18:19], v10 offset:45568
    s_waitcnt lgkmcnt(5)
    v_mfma_f32_32x32x16_bf16 v[80:95], v[32:35], v[180:183], v[80:95]
    ds_read_b64_tr_b16 v[20:21], v11 offset:45056
    ds_read_b64_tr_b16 v[22:23], v11 offset:45568
    s_waitcnt lgkmcnt(5)
    v_mfma_f32_32x32x16_bf16 v[96:111], v[180:183], v[36:39], v[96:111]
    ds_read_b64_tr_b16 v[24:25], v12 offset:45056
    ds_read_b64_tr_b16 v[26:27], v12 offset:45568
    s_waitcnt vmcnt(6)
    s_barrier
    s_waitcnt lgkmcnt(4)
    v_mfma_f32_32x32x16_bf16 v[64:79], v[16:19], v[184:187], v[64:79]
    ds_read_b128 v[188:191], v43 offset:40960
    ds_read_b64_tr_b16 v[28:29], v10 offset:47104
    ds_read_b64_tr_b16 v[30:31], v10 offset:47616
    s_add_u32 m0, s10, 81920
    s_movk_i32 s57, 768
    buffer_load_dwordx4 v3, s[28:31], s57 offen lds
    s_waitcnt lgkmcnt(5)
    v_mfma_f32_32x32x16_bf16 v[80:95], v[20:23], v[184:187], v[80:95]
    ds_read_b64_tr_b16 v[32:33], v11 offset:47104
    ds_read_b64_tr_b16 v[34:35], v11 offset:47616
    s_add_u32 m0, s10, 82944
    s_movk_i32 s57, 768
    buffer_load_dwordx4 v4, s[28:31], s57 offen lds
    s_waitcnt lgkmcnt(5)
    v_mfma_f32_32x32x16_bf16 v[96:111], v[184:187], v[24:27], v[96:111]
    ds_read_b64_tr_b16 v[36:37], v12 offset:47104
    ds_read_b64_tr_b16 v[38:39], v12 offset:47616
    s_waitcnt lgkmcnt(4)
    v_mfma_f32_32x32x16_bf16 v[64:79], v[28:31], v[188:191], v[64:79]
    v_subrev_u32 v40, 0x14000, v40
    v_subrev_u32 v41, 0x14000, v41
    v_subrev_u32 v42, 0x14000, v42
    v_subrev_u32 v43, 0x14000, v43
    v_subrev_u32 v10, 0x14000, v10
    v_subrev_u32 v11, 0x14000, v11
    v_subrev_u32 v12, 0x14000, v12
    ds_read_b128 v[192:195], v40 offset:0
    ds_read_b64_tr_b16 v[16:17], v10 offset:0
    ds_read_b64_tr_b16 v[18:19], v10 offset:512
    s_add_u32 m0, s11, 81920
    s_add_u32 s100, s100, s62
    buffer_load_dwordx4 v5, s[96:99], s100 offen lds
    s_waitcnt lgkmcnt(5)
    v_mfma_f32_32x32x16_bf16 v[80:95], v[32:35], v[188:191], v[80:95]
    ds_read_b64_tr_b16 v[20:21], v11 offset:0
    ds_read_b64_tr_b16 v[22:23], v11 offset:512
    s_add_u32 m0, s0, 81920
    s_nop 0
    buffer_load_dwordx4 v6, s[96:99], s100 offen lds
    s_waitcnt lgkmcnt(5)
    v_mfma_f32_32x32x16_bf16 v[96:111], v[188:191], v[36:39], v[96:111]
    ds_read_b64_tr_b16 v[24:25], v12 offset:0
    ds_read_b64_tr_b16 v[26:27], v12 offset:512
    s_waitcnt lgkmcnt(4)
    v_mfma_f32_32x32x16_bf16 v[64:79], v[16:19], v[192:195], v[64:79]
    ds_read_b128 v[196:199], v41 offset:0
    ds_read_b64_tr_b16 v[28:29], v10 offset:2048
    ds_read_b64_tr_b16 v[30:31], v10 offset:2560
    s_add_u32 m0, s1, 81920
    s_nop 0
    buffer_load_dwordx4 v7, s[96:99], s100 offen lds
    s_waitcnt lgkmcnt(5)
    v_mfma_f32_32x32x16_bf16 v[80:95], v[20:23], v[192:195], v[80:95]
    ds_read_b64_tr_b16 v[32:33], v11 offset:2048
    ds_read_b64_tr_b16 v[34:35], v11 offset:2560
    s_waitcnt lgkmcnt(5)
    v_mfma_f32_32x32x16_bf16 v[96:111], v[192:195], v[24:27], v[96:111]
    ds_read_b64_tr_b16 v[36:37], v12 offset:2048
    ds_read_b64_tr_b16 v[38:39], v12 offset:2560
    s_waitcnt lgkmcnt(4)
    v_mfma_f32_32x32x16_bf16 v[64:79], v[28:31], v[196:199], v[64:79]
    ds_read_b128 v[200:203], v42 offset:0
    ds_read_b64_tr_b16 v[16:17], v10 offset:4096
    ds_read_b64_tr_b16 v[18:19], v10 offset:4608
    s_waitcnt lgkmcnt(5)
    v_mfma_f32_32x32x16_bf16 v[80:95], v[32:35], v[196:199], v[80:95]
    ds_read_b64_tr_b16 v[20:21], v11 offset:4096
    ds_read_b64_tr_b16 v[22:23], v11 offset:4608
    s_waitcnt lgkmcnt(5)
    v_mfma_f32_32x32x16_bf16 v[96:111], v[196:199], v[36:39], v[96:111]
    ds_read_b64_tr_b16 v[24:25], v12 offset:4096
    ds_read_b64_tr_b16 v[26:27], v12 offset:4608
    s_waitcnt vmcnt(5)
    s_barrier
    v_readfirstlane_b32 s59, v44
    s_getreg_b32 s56, hwreg(HW_REG_XCC_ID, 0, 4)
    s_mul_i32 s57, s56, s56
    s_lshl_b32 s57, s57, 16
    s_lshl_b32 s58, s56, 8
    s_add_u32 s57, s57, s58
    s_add_u32 s57, s57, 1
    s_lshl_b32 s23, s57, 5
    s_add_u32 s58, s54, 48
    s_lshl_b32 s58, s58, 8
    s_cmp_ge_u32 s59, 1
    s_cselect_b32 s58, s58, 0x7fff0000
    s_cselect_b32 s12, 1, 0
    v_mov_b32 v48, 0x7fff0000
    v_mov_b32 v49, s58
    v_cmp_eq_u32 vcc, 0, v0
    s_nop 1
    v_cndmask_b32 v48, v48, v49, vcc
    v_mov_b32 v49, s57
    buffer_atomic_add v49, v48, s[32:35], 0 offen sc1
    s_waitcnt lgkmcnt(4)
    v_mfma_f32_32x32x16_bf16 v[64:79], v[16:19], v[200:203], v[64:79]
    ds_read_b128 v[204:207], v43 offset:0
    ds_read_b64_tr_b16 v[28:29], v10 offset:6144
    ds_read_b64_tr_b16 v[30:31], v10 offset:6656
    s_add_u32 m0, s10, 122880
    s_movk_i32 s57, 896
    buffer_load_dwordx4 v3, s[28:31], s57 offen lds
    s_waitcnt lgkmcnt(5)
    v_mfma_f32_32x32x16_bf16 v[80:95], v[20:23], v[200:203], v[80:95]
    ds_read_b64_tr_b16 v[32:33], v11 offset:6144
    ds_read_b64_tr_b16 v[34:35], v11 offset:6656
    s_add_u32 m0, s10, 123904
    s_movk_i32 s57, 896
    buffer_load_dwordx4 v4, s[28:31], s57 offen lds
    s_waitcnt lgkmcnt(5)
    v_mfma_f32_32x32x16_bf16 v[96:111], v[200:203], v[24:27], v[96:111]
    ds_read_b64_tr_b16 v[36:37], v12 offset:6144
    ds_read_b64_tr_b16 v[38:39], v12 offset:6656
    s_waitcnt lgkmcnt(4)
    v_mfma_f32_32x32x16_bf16 v[64:79], v[28:31], v[204:207], v[64:79]
    ds_read_b128 v[208:211], v40 offset:40960
    ds_read_b64_tr_b16 v[16:17], v10 offset:40960
    ds_read_b64_tr_b16 v[18:19], v10 offset:41472
    s_add_u32 m0, s11, 122880
    s_add_u32 s100, s100, s62
    buffer_load_dwordx4 v5, s[96:99], s100 offen lds
    s_waitcnt lgkmcnt(5)
    v_mfma_f32_32x32x16_bf16 v[80:95], v[32:35], v[204:207], v[80:95]
    ds_read_b64_tr_b16 v[20:21], v11 offset:40960
    ds_read_b64_tr_b16 v[22:23], v11 offset:41472
    s_add_u32 m0, s0, 122880
    s_nop 0
    buffer_load_dwordx4 v6, s[96:99], s100 offen lds
    s_waitcnt lgkmcnt(5)
    v_mfma_f32_32x32x16_bf16 v[96:111], v[204:207], v[36:39], v[96:111]
    ds_read_b64_tr_b16 v[24:25], v12 offset:40960
    ds_read_b64_tr_b16 v[26:27], v12 offset:41472
    s_waitcnt lgkmcnt(4)
    v_mfma_f32_32x32x16_bf16 v[64:79], v[16:19], v[208:211], v[64:79]
    ds_read_b128 v[212:215], v41 offset:40960
    ds_read_b64_tr_b16 v[28:29], v10 offset:43008
    ds_read_b64_tr_b16 v[30:31], v10 offset:43520
    s_add_u32 m0, s1, 122880
    s_nop 0
    buffer_load_dwordx4 v7, s[96:99], s100 offen lds
    s_waitcnt lgkmcnt(5)
    v_mfma_f32_32x32x16_bf16 v[80:95], v[20:23], v[208:211], v[80:95]
    ds_read_b64_tr_b16 v[32:33], v11 offset:43008
    ds_read_b64_tr_b16 v[34:35], v11 offset:43520
    s_waitcnt lgkmcnt(5)
    v_mfma_f32_32x32x16_bf16 v[96:111], v[208:211], v[24:27], v[96:111]
    ds_read_b64_tr_b16 v[36:37], v12 offset:43008
    ds_read_b64_tr_b16 v[38:39], v12 offset:43520
    s_waitcnt lgkmcnt(4)
    v_mfma_f32_32x32x16_bf16 v[64:79], v[28:31], v[212:215], v[64:79]
    ds_read_b128 v[216:219], v42 offset:40960
    ds_read_b64_tr_b16 v[16:17], v10 offset:45056
    ds_read_b64_tr_b16 v[18:19], v10 offset:45568
    s_waitcnt lgkmcnt(5)
    v_mfma_f32_32x32x16_bf16 v[80:95], v[32:35], v[212:215], v[80:95]
    ds_read_b64_tr_b16 v[20:21], v11 offset:45056
    ds_read_b64_tr_b16 v[22:23], v11 offset:45568
    s_waitcnt lgkmcnt(5)
    v_mfma_f32_32x32x16_bf16 v[96:111], v[212:215], v[36:39], v[96:111]
    ds_read_b64_tr_b16 v[24:25], v12 offset:45056
    ds_read_b64_tr_b16 v[26:27], v12 offset:45568
    s_waitcnt vmcnt(6)
    s_barrier
    s_waitcnt lgkmcnt(4)
    v_mfma_f32_32x32x16_bf16 v[64:79], v[16:19], v[216:219], v[64:79]
    ds_read_b128 v[220:223], v43 offset:40960
    ds_read_b64_tr_b16 v[28:29], v10 offset:47104
    ds_read_b64_tr_b16 v[30:31], v10 offset:47616
    s_add_u32 m0, s26, 0
    s_mov_b32 s57, 0
    buffer_load_dwordx4 v8, s[36:39], s57 offen lds
    s_waitcnt lgkmcnt(5)
    v_mfma_f32_32x32x16_bf16 v[80:95], v[20:23], v[216:219], v[80:95]
    ds_read_b64_tr_b16 v[32:33], v11 offset:47104
    ds_read_b64_tr_b16 v[34:35], v11 offset:47616
    s_add_u32 m0, s26, 8192
    s_mov_b32 s57, 0
    buffer_load_dwordx4 v9, s[4:7], s57 offen lds
    s_waitcnt lgkmcnt(5)
    v_mfma_f32_32x32x16_bf16 v[96:111], v[216:219], v[24:27], v[96:111]
    ds_read_b64_tr_b16 v[36:37], v12 offset:47104
    ds_read_b64_tr_b16 v[38:39], v12 offset:47616
    s_waitcnt lgkmcnt(4)
    v_mfma_f32_32x32x16_bf16 v[64:79], v[28:31], v[220:223], v[64:79]
    v_add_u32 v40, 0x14000, v40
    v_add_u32 v41, 0x14000, v41
    v_add_u32 v42, 0x14000, v42
    v_add_u32 v43, 0x14000, v43
    v_add_u32 v10, 0x14000, v10
    v_add_u32 v11, 0x14000, v11
    v_add_u32 v12, 0x14000, v12
    ds_read_b128 v[224:227], v40 offset:0
    ds_read_b64_tr_b16 v[16:17], v10 offset:0
    ds_read_b64_tr_b16 v[18:19], v10 offset:512
    s_add_u32 m0, s26, 16384
    s_mov_b32 s57, 229376
    buffer_load_dwordx4 v8, s[36:39], s57 offen lds
    s_waitcnt lgkmcnt(5)
    v_mfma_f32_32x32x16_bf16 v[80:95], v[32:35], v[220:223], v[80:95]
    ds_read_b64_tr_b16 v[20:21], v11 offset:0
    ds_read_b64_tr_b16 v[22:23], v11 offset:512
    s_add_u32 m0, s26, 24576
    s_mov_b32 s57, 229376
    buffer_load_dwordx4 v9, s[4:7], s57 offen lds
    s_waitcnt lgkmcnt(5)
    v_mfma_f32_32x32x16_bf16 v[96:111], v[220:223], v[36:39], v[96:111]
    ds_read_b64_tr_b16 v[24:25], v12 offset:0
    ds_read_b64_tr_b16 v[26:27], v12 offset:512
    s_waitcnt lgkmcnt(4)
    v_mfma_f32_32x32x16_bf16 v[64:79], v[16:19], v[224:227], v[64:79]
    ds_read_b128 v[228:231], v41 offset:0
    ds_read_b64_tr_b16 v[28:29], v10 offset:2048
    ds_read_b64_tr_b16 v[30:31], v10 offset:2560
    s_waitcnt lgkmcnt(5)
    v_mfma_f32_32x32x16_bf16 v[80:95], v[20:23], v[224:227], v[80:95]
    ds_read_b64_tr_b16 v[32:33], v11 offset:2048
    ds_read_b64_tr_b16 v[34:35], v11 offset:2560
    s_waitcnt lgkmcnt(5)
    v_mfma_f32_32x32x16_bf16 v[96:111], v[224:227], v[24:27], v[96:111]
    ds_read_b64_tr_b16 v[36:37], v12 offset:2048
    ds_read_b64_tr_b16 v[38:39], v12 offset:2560
    s_waitcnt lgkmcnt(4)
    v_mfma_f32_32x32x16_bf16 v[64:79], v[28:31], v[228:231], v[64:79]
    ds_read_b128 v[232:235], v42 offset:0
    ds_read_b64_tr_b16 v[16:17], v10 offset:4096
    ds_read_b64_tr_b16 v[18:19], v10 offset:4608
    s_waitcnt lgkmcnt(5)
    v_mfma_f32_32x32x16_bf16 v[80:95], v[32:35], v[228:231], v[80:95]
    ds_read_b64_tr_b16 v[20:21], v11 offset:4096
    ds_read_b64_tr_b16 v[22:23], v11 offset:4608
    s_waitcnt lgkmcnt(5)
    v_mfma_f32_32x32x16_bf16 v[96:111], v[228:231], v[36:39], v[96:111]
    ds_read_b64_tr_b16 v[24:25], v12 offset:4096
    ds_read_b64_tr_b16 v[26:27], v12 offset:4608
    s_waitcnt vmcnt(4)
    s_barrier
    s_waitcnt lgkmcnt(4)
    v_mfma_f32_32x32x16_bf16 v[64:79], v[16:19], v[232:235], v[64:79]
    ds_read_b128 v[236:239], v43 offset:0
    ds_read_b64_tr_b16 v[28:29], v10 offset:6144
    ds_read_b64_tr_b16 v[30:31], v10 offset:6656
    s_add_u32 m0, s26, 40960
    s_mov_b32 s57, 458752
    buffer_load_dwordx4 v8, s[36:39], s57 offen lds
    s_waitcnt lgkmcnt(5)
    v_mfma_f32_32x32x16_bf16 v[80:95], v[20:23], v[232:235], v[80:95]
    ds_read_b64_tr_b16 v[32:33], v11 offset:6144
    ds_read_b64_tr_b16 v[34:35], v11 offset:6656
    s_add_u32 m0, s26, 49152
    s_mov_b32 s57, 458752
    buffer_load_dwordx4 v9, s[4:7], s57 offen lds
    s_waitcnt lgkmcnt(5)
    v_mfma_f32_32x32x16_bf16 v[96:111], v[232:235], v[24:27], v[96:111]
    ds_read_b64_tr_b16 v[36:37], v12 offset:6144
    ds_read_b64_tr_b16 v[38:39], v12 offset:6656
    s_waitcnt lgkmcnt(4)
    v_mfma_f32_32x32x16_bf16 v[64:79], v[28:31], v[236:239], v[64:79]
    ds_read_b128 v[240:243], v40 offset:40960
    ds_read_b64_tr_b16 v[16:17], v10 offset:40960
    ds_read_b64_tr_b16 v[18:19], v10 offset:41472
    s_add_u32 m0, s26, 57344
    s_mov_b32 s57, 688128
    buffer_load_dwordx4 v8, s[36:39], s57 offen lds
    s_waitcnt lgkmcnt(5)
    v_mfma_f32_32x32x16_bf16 v[80:95], v[32:35], v[236:239], v[80:95]
    ds_read_b64_tr_b16 v[20:21], v11 offset:40960
    ds_read_b64_tr_b16 v[22:23], v11 offset:41472
    s_add_u32 m0, s26, 65536
    s_mov_b32 s57, 688128
    buffer_load_dwordx4 v9, s[4:7], s57 offen lds
    s_waitcnt lgkmcnt(5)
    v_mfma_f32_32x32x16_bf16 v[96:111], v[236:239], v[36:39], v[96:111]
    ds_read_b64_tr_b16 v[24:25], v12 offset:40960
    ds_read_b64_tr_b16 v[26:27], v12 offset:41472
    s_waitcnt lgkmcnt(4)
    v_mfma_f32_32x32x16_bf16 v[64:79], v[16:19], v[240:243], v[64:79]
    ds_read_b128 v[244:247], v41 offset:40960
    ds_read_b64_tr_b16 v[28:29], v10 offset:43008
    ds_read_b64_tr_b16 v[30:31], v10 offset:43520
    s_waitcnt lgkmcnt(5)
    v_mfma_f32_32x32x16_bf16 v[80:95], v[20:23], v[240:243], v[80:95]
    ds_read_b64_tr_b16 v[32:33], v11 offset:43008
    ds_read_b64_tr_b16 v[34:35], v11 offset:43520
    s_waitcnt lgkmcnt(5)
    v_mfma_f32_32x32x16_bf16 v[96:111], v[240:243], v[24:27], v[96:111]
    ds_read_b64_tr_b16 v[36:37], v12 offset:43008
    ds_read_b64_tr_b16 v[38:39], v12 offset:43520
    s_waitcnt lgkmcnt(4)
    v_mfma_f32_32x32x16_bf16 v[64:79], v[28:31], v[244:247], v[64:79]
    ds_read_b128 v[248:251], v42 offset:40960
    ds_read_b64_tr_b16 v[16:17], v10 offset:45056
    ds_read_b64_tr_b16 v[18:19], v10 offset:45568
    s_waitcnt lgkmcnt(5)
    v_mfma_f32_32x32x16_bf16 v[80:95], v[32:35], v[244:247], v[80:95]
    ds_read_b64_tr_b16 v[20:21], v11 offset:45056
    ds_read_b64_tr_b16 v[22:23], v11 offset:45568
    s_waitcnt lgkmcnt(5)
    v_mfma_f32_32x32x16_bf16 v[96:111], v[244:247], v[36:39], v[96:111]
    ds_read_b64_tr_b16 v[24:25], v12 offset:45056
    ds_read_b64_tr_b16 v[26:27], v12 offset:45568
    s_waitcnt vmcnt(6)
    s_barrier
    s_add_u32 s58, s54, 48
    s_lshl_b32 s58, s58, 8
    v_mov_b32 v45, s58
    buffer_load_dword v44, v45, s[32:35], 0 offen sc1
    s_waitcnt lgkmcnt(4)
    v_mfma_f32_32x32x16_bf16 v[64:79], v[16:19], v[248:251], v[64:79]
    ds_read_b128 v[252:255], v43 offset:40960
    ds_read_b64_tr_b16 v[28:29], v10 offset:47104
    ds_read_b64_tr_b16 v[30:31], v10 offset:47616
    s_add_u32 m0, s26, 98304
    s_mov_b32 s57, 917504
    buffer_load_dwordx4 v8, s[36:39], s57 offen lds
    s_waitcnt lgkmcnt(5)
    v_mfma_f32_32x32x16_bf16 v[80:95], v[20:23], v[248:251], v[80:95]
    ds_read_b64_tr_b16 v[32:33], v11 offset:47104
    ds_read_b64_tr_b16 v[34:35], v11 offset:47616
    s_add_u32 m0, s26, 106496
    s_mov_b32 s57, 917504
    buffer_load_dwordx4 v9, s[4:7], s57 offen lds
    s_waitcnt lgkmcnt(5)
    v_mfma_f32_32x32x16_bf16 v[96:111], v[248:251], v[24:27], v[96:111]
    ds_read_b64_tr_b16 v[36:37], v12 offset:47104
    ds_read_b64_tr_b16 v[38:39], v12 offset:47616
    s_waitcnt lgkmcnt(4)
    v_mfma_f32_32x32x16_bf16 v[64:79], v[28:31], v[252:255], v[64:79]
    ds_read_b64_tr_b16 v[16:17], v14 offset:0
    ds_read_b64_tr_b16 v[18:19], v14 offset:512
    s_add_u32 m0, s26, 81920
    s_mov_b32 s57, 1146880
    buffer_load_dwordx4 v8, s[36:39], s57 offen lds
    s_waitcnt lgkmcnt(4)
    v_mfma_f32_32x32x16_bf16 v[80:95], v[32:35], v[252:255], v[80:95]
    ds_read_b64_tr_b16 v[20:21], v15 offset:0
    ds_read_b64_tr_b16 v[22:23], v15 offset:512
    s_add_u32 m0, s26, 90112
    s_mov_b32 s57, 1146880
    buffer_load_dwordx4 v9, s[4:7], s57 offen lds
    s_waitcnt lgkmcnt(4)
    v_mfma_f32_32x32x16_bf16 v[96:111], v[252:255], v[36:39], v[96:111]
    s_waitcnt vmcnt(4)
    v_readfirstlane_b32 s56, v44
    s_nop 0
    s_cmp_eq_u32 s56, s23
    s_cselect_b32 s12, s12, 0
    s_lshl_b32 s56, s67, 3
    s_add_u32 s56, s56, s50
    s_lshl_b32 s57, s56, 3
    s_set_gpr_idx_on s57, 0x1
    v_mov_b32 v120, v128
    v_mov_b32 v121, v129
    v_mov_b32 v122, v130
    v_mov_b32 v123, v131
    v_mov_b32 v124, v132
    v_mov_b32 v125, v133
    v_mov_b32 v126, v134
    v_mov_b32 v127, v135
    s_set_gpr_idx_off
    v_mfma_f32_32x32x16_bf16 v[48:63], v[112:115], v[120:123], 0
    v_mfma_f32_32x32x16_bf16 v[48:63], v[116:119], v[124:127], v[48:63]
    s_lshl_b32 s57, s56, 13
    s_add_u32 s57, s57, 0x10000
    s_lshl_b32 s58, s53, 7
    s_add_u32 s19, s57, s58
    s_cmp_eq_u32 s52, 0
    s_cselect_b32 s57, 32, 0
    v_lshlrev_b32 v43, 2, v2
    v_mov_b32 v42, 0x7fff0000
    v_cmp_gt_u32 vcc, s57, v2
    s_nop 1
    v_cndmask_b32 v43, v42, v43, vcc
    s_lshl_b32 s56, s50, 2
    s_lshl_b32 s57, s52, 1
    s_add_u32 s56, s56, s57
    s_lshl_b32 s57, s56, 6
    s_add_u32 s57, s57, s53
    s_lshl_b32 s18, s57, 10
    s_lshl_b32 s61, s50, 4
    s_add_u32 s61, s61, s49
    s_lshl_b32 s61, s61, 7
    s_lshl_b32 s56, s52, 6
    s_add_u32 s61, s61, s56
    s_lshl_b32 s56, s51, 3
    s_add_u32 s61, s61, s56
    s_mov_b32 s56, s65
    s_mov_b32 s57, s65
    v_pk_mul_f32 v[64:65], v[64:65], s[56:57]
    v_pk_mul_f32 v[66:67], v[66:67], s[56:57]
    v_pk_mul_f32 v[68:69], v[68:69], s[56:57]
    v_pk_mul_f32 v[70:71], v[70:71], s[56:57]
    v_pk_mul_f32 v[80:81], v[80:81], s[56:57]
    v_pk_mul_f32 v[82:83], v[82:83], s[56:57]
    v_pk_mul_f32 v[84:85], v[84:85], s[56:57]
    v_pk_mul_f32 v[86:87], v[86:87], s[56:57]
    v_mov_b32 v42, v48
    v_cvt_pk_bf16_f32 v52, v72, v73
    v_cvt_pk_bf16_f32 v53, v74, v75
    v_cvt_pk_bf16_f32 v54, v76, v77
    v_cvt_pk_bf16_f32 v55, v78, v79
    v_cvt_pk_bf16_f32 v60, v88, v89
    v_cvt_pk_bf16_f32 v61, v90, v91
    v_cvt_pk_bf16_f32 v62, v92, v93
    v_cvt_pk_bf16_f32 v63, v94, v95
    v_cvt_pk_bf16_f32 v120, v96, v97
    v_cvt_pk_bf16_f32 v121, v98, v99
    v_cvt_pk_bf16_f32 v122, v100, v101
    v_cvt_pk_bf16_f32 v123, v102, v103
    v_cvt_pk_bf16_f32 v124, v104, v105
    v_cvt_pk_bf16_f32 v125, v106, v107
    v_cvt_pk_bf16_f32 v126, v108, v109
    v_cvt_pk_bf16_f32 v127, v110, v111
    v_cvt_pk_bf16_f32 v48, v64, v65
    v_cvt_pk_bf16_f32 v49, v66, v67
    v_cvt_pk_bf16_f32 v50, v68, v69
    v_cvt_pk_bf16_f32 v51, v70, v71
    v_cvt_pk_bf16_f32 v56, v80, v81
    v_cvt_pk_bf16_f32 v57, v82, v83
    v_cvt_pk_bf16_f32 v58, v84, v85
    v_cvt_pk_bf16_f32 v59, v86, v87
    v_bfe_u32 v40, v2, 4, 1
    v_lshlrev_b32 v40, 16, v40
    v_lshrrev_b32 v41, 5, v2
    v_lshl_add_u32 v40, v41, 8, v40
    v_and_b32 v41, 15, v2
    v_lshl_add_u32 v40, v41, 4, v40
    v_pk_mul_f32 v[96:97], v[64:65], v[64:65]
    v_pk_mul_f32 v[98:99], v[72:73], v[72:73]
    v_pk_mul_f32 v[100:101], v[80:81], v[80:81]
    v_pk_mul_f32 v[102:103], v[88:89], v[88:89]
    v_pk_fma_f32 v[96:97], v[66:67], v[66:67], v[96:97]
    v_pk_fma_f32 v[98:99], v[74:75], v[74:75], v[98:99]
    v_pk_fma_f32 v[100:101], v[82:83], v[82:83], v[100:101]
    v_pk_fma_f32 v[102:103], v[90:91], v[90:91], v[102:103]
    v_pk_fma_f32 v[96:97], v[68:69], v[68:69], v[96:97]
    v_pk_fma_f32 v[98:99], v[76:77], v[76:77], v[98:99]
    v_pk_fma_f32 v[100:101], v[84:85], v[84:85], v[100:101]
    v_pk_fma_f32 v[102:103], v[92:93], v[92:93], v[102:103]
    v_pk_fma_f32 v[96:97], v[70:71], v[70:71], v[96:97]
    v_pk_fma_f32 v[98:99], v[78:79], v[78:79], v[98:99]
    v_pk_fma_f32 v[100:101], v[86:87], v[86:87], v[100:101]
    v_pk_fma_f32 v[102:103], v[94:95], v[94:95], v[102:103]
    v_add_f32 v96, v96, v97
    v_add_f32 v98, v98, v99
    v_add_f32 v100, v100, v101
    v_add_f32 v102, v102, v103
    v_permlane32_swap_b32 v96, v98
    s_nop 0
    v_permlane32_swap_b32 v100, v102
    v_add_f32 v96, v96, v98
    v_add_f32 v100, v100, v102
    s_add_u32 s56, s61, 0x4000
    s_add_u32 s57, s61, 0x4004
    v_mov_b32 v104, 0x7fff0000
    v_mov_b32 v105, s56
    v_cmp_eq_u32 vcc, 31, v2
    v_max_f32_dpp v96, v96, v96 row_shr:1 row_mask:0xf bank_mask:0xf
    v_max_f32_dpp v100, v100, v100 row_shr:1 row_mask:0xf bank_mask:0xf
    v_cndmask_b32 v104, v104, v105, vcc
    v_mov_b32 v105, s57
    v_max_f32_dpp v96, v96, v96 row_shr:2 row_mask:0xf bank_mask:0xf
    v_max_f32_dpp v100, v100, v100 row_shr:2 row_mask:0xf bank_mask:0xf
    v_cmp_eq_u32 vcc, 63, v2
    v_max_f32_dpp v96, v96, v96 row_shr:4 row_mask:0xf bank_mask:0xf
    v_max_f32_dpp v100, v100, v100 row_shr:4 row_mask:0xf bank_mask:0xf
    v_cndmask_b32 v104, v104, v105, vcc
    v_max_f32_dpp v96, v96, v96 row_shr:8 row_mask:0xf bank_mask:0xf
    v_max_f32_dpp v100, v100, v100 row_shr:8 row_mask:0xf bank_mask:0xf
    s_nop 0
    v_max_f32_dpp v96, v96, v96 row_bcast:15 row_mask:0xa bank_mask:0xf
    v_max_f32_dpp v100, v100, v100 row_bcast:15 row_mask:0xa bank_mask:0xf
    s_waitcnt lgkmcnt(2)
    v_mfma_f32_32x32x16_bf16 v[64:79], v[16:19], v[128:131], 0
    ds_read_b64_tr_b16 v[28:29], v14 offset:2048
    ds_read_b64_tr_b16 v[30:31], v14 offset:2560
    s_add_u32 s57, s18, 0x400000
    s_cmp_eq_u32 s12, 0
    s_cbranch_scc1 L_wt1
    buffer_store_dwordx4 v[52:55], v13, s[32:35], s57 offen
    s_branch L_st1
L_wt1:
    buffer_store_dwordx4 v[52:55], v13, s[32:35], s57 offen sc1
L_st1:
    s_waitcnt lgkmcnt(2)
    v_mfma_f32_32x32x16_bf16 v[80:95], v[20:23], v[128:131], 0
    ds_read_b64_tr_b16 v[32:33], v15 offset:2048
    ds_read_b64_tr_b16 v[34:35], v15 offset:2560
    s_add_u32 s57, s18, 0x410000
    s_cmp_eq_u32 s12, 0
    s_cbranch_scc1 L_wt2
    buffer_store_dwordx4 v[60:63], v13, s[32:35], s57 offen
    s_branch L_st2
L_wt2:
    buffer_store_dwordx4 v[60:63], v13, s[32:35], s57 offen sc1
L_st2:
    s_waitcnt lgkmcnt(2)
    v_mfma_f32_32x32x16_bf16 v[64:79], v[28:31], v[132:135], v[64:79]
    ds_read_b64_tr_b16 v[16:17], v14 offset:4096
    ds_read_b64_tr_b16 v[18:19], v14 offset:4608
    s_add_u32 s57, s18, 0x600000
    s_cmp_eq_u32 s12, 0
    s_cbranch_scc1 L_wt3
    buffer_store_dwordx4 v[120:123], v40, s[32:35], s57 offen
    s_branch L_st3
L_wt3:
    buffer_store_dwordx4 v[120:123], v40, s[32:35], s57 offen sc1
L_st3:
    s_waitcnt lgkmcnt(2)
    v_mfma_f32_32x32x16_bf16 v[80:95], v[32:35], v[132:135], v[80:95]
    ds_read_b64_tr_b16 v[20:21], v15 offset:4096
    ds_read_b64_tr_b16 v[22:23], v15 offset:4608
    s_add_u32 s57, s18, 0x600000
    s_cmp_eq_u32 s12, 0
    s_cbranch_scc1 L_wt4
    buffer_store_dwordx4 v[124:127], v40, s[32:35], s57 offen offset:512
    s_branch L_st4
L_wt4:
    buffer_store_dwordx4 v[124:127], v40, s[32:35], s57 offen offset:512 sc1
L_st4:
    s_barrier
    buffer_load_dword v44, v47, s[40:43], 0 offen sc1
    s_waitcnt lgkmcnt(2)
    v_mfma_f32_32x32x16_bf16 v[64:79], v[16:19], v[136:139], v[64:79]
    ds_read_b64_tr_b16 v[28:29], v14 offset:6144
    ds_read_b64_tr_b16 v[30:31], v14 offset:6656
    s_add_u32 s57, s18, 0x200000
    s_cmp_eq_u32 s12, 0
    s_cbranch_scc1 L_wt5
    buffer_store_dwordx4 v[48:51], v13, s[32:35], s57 offen
    s_branch L_st5
L_wt5:
    buffer_store_dwordx4 v[48:51], v13, s[32:35], s57 offen sc1
L_st5:
    s_waitcnt lgkmcnt(2)
    v_mfma_f32_32x32x16_bf16 v[80:95], v[20:23], v[136:139], v[80:95]
    ds_read_b64_tr_b16 v[32:33], v15 offset:6144
    ds_read_b64_tr_b16 v[34:35], v15 offset:6656
    s_add_u32 s57, s18, 0x210000
    s_cmp_eq_u32 s12, 0
    s_cbranch_scc1 L_wt6
    buffer_store_dwordx4 v[56:59], v13, s[32:35], s57 offen
    s_branch L_st6
L_wt6:
    buffer_store_dwordx4 v[56:59], v13, s[32:35], s57 offen sc1
L_st6:
    s_waitcnt lgkmcnt(2)
    v_mfma_f32_32x32x16_bf16 v[64:79], v[28:31], v[140:143], v[64:79]
    ds_read_b64_tr_b16 v[16:17], v14 offset:16384
    ds_read_b64_tr_b16 v[18:19], v14 offset:16896
    s_cmp_eq_u32 s12, 0
    s_cbranch_scc1 L_wt7
    buffer_store_dword v96, v104, s[32:35], 0 offen
    s_branch L_st7
L_wt7:
    buffer_store_dword v96, v104, s[32:35], 0 offen sc1
L_st7:
    s_waitcnt lgkmcnt(2)
    v_mfma_f32_32x32x16_bf16 v[80:95], v[32:35], v[140:143], v[80:95]
    ds_read_b64_tr_b16 v[20:21], v15 offset:16384
    ds_read_b64_tr_b16 v[22:23], v15 offset:16896
    s_cmp_eq_u32 s12, 0
    s_cbranch_scc1 L_wt8
    buffer_store_dword v100, v104, s[32:35], 0 offen offset:32
    s_branch L_st8
L_wt8:
    buffer_store_dword v100, v104, s[32:35], 0 offen offset:32 sc1
L_st8:
    s_waitcnt lgkmcnt(2)
    v_mfma_f32_32x32x16_bf16 v[64:79], v[16:19], v[144:147], v[64:79]
    ds_read_b64_tr_b16 v[28:29], v14 offset:18432
    ds_read_b64_tr_b16 v[30:31], v14 offset:18944
    s_add_u32 m0, s26, 131072
    s_mov_b32 s57, 1376256
    buffer_load_dwordx4 v8, s[36:39], s57 offen lds
    s_waitcnt lgkmcnt(2)
    v_mfma_f32_32x32x16_bf16 v[80:95], v[20:23], v[144:147], v[80:95]
    ds_read_b64_tr_b16 v[32:33], v15 offset:18432
    ds_read_b64_tr_b16 v[34:35], v15 offset:18944
    s_add_u32 m0, s26, 139264
    s_mov_b32 s57, 1376256
    buffer_load_dwordx4 v9, s[4:7], s57 offen lds
    s_waitcnt lgkmcnt(2)
    v_mfma_f32_32x32x16_bf16 v[64:79], v[28:31], v[148:151], v[64:79]
    ds_read_b64_tr_b16 v[16:17], v14 offset:20480
    ds_read_b64_tr_b16 v[18:19], v14 offset:20992
    s_add_u32 m0, s26, 147456
    s_mov_b32 s57, 1605632
    buffer_load_dwordx4 v8, s[36:39], s57 offen lds
    s_waitcnt lgkmcnt(2)
    v_mfma_f32_32x32x16_bf16 v[80:95], v[32:35], v[148:151], v[80:95]
    ds_read_b64_tr_b16 v[20:21], v15 offset:20480
    ds_read_b64_tr_b16 v[22:23], v15 offset:20992
    s_add_u32 m0, s26, 155648
    s_mov_b32 s57, 1605632
    buffer_load_dwordx4 v9, s[4:7], s57 offen lds
    s_barrier
    s_waitcnt lgkmcnt(2)
    v_mfma_f32_32x32x16_bf16 v[64:79], v[16:19], v[152:155], v[64:79]
    ds_read_b64_tr_b16 v[28:29], v14 offset:22528
    ds_read_b64_tr_b16 v[30:31], v14 offset:23040
    s_waitcnt lgkmcnt(2)
    v_mfma_f32_32x32x16_bf16 v[80:95], v[20:23], v[152:155], v[80:95]
    ds_read_b64_tr_b16 v[32:33], v15 offset:22528
    ds_read_b64_tr_b16 v[34:35], v15 offset:23040
    s_waitcnt lgkmcnt(2)
    v_mfma_f32_32x32x16_bf16 v[64:79], v[28:31], v[156:159], v[64:79]
    ds_read_b64_tr_b16 v[16:17], v14 offset:40960
    ds_read_b64_tr_b16 v[18:19], v14 offset:41472
    s_waitcnt lgkmcnt(2)
    v_mfma_f32_32x32x16_bf16 v[80:95], v[32:35], v[156:159], v[80:95]
    ds_read_b64_tr_b16 v[20:21], v15 offset:40960
    ds_read_b64_tr_b16 v[22:23], v15 offset:41472
    s_waitcnt lgkmcnt(2)
    v_mfma_f32_32x32x16_bf16 v[64:79], v[16:19], v[160:163], v[64:79]
    ds_read_b64_tr_b16 v[28:29], v14 offset:43008
    ds_read_b64_tr_b16 v[30:31], v14 offset:43520
    s_waitcnt lgkmcnt(2)
    v_mfma_f32_32x32x16_bf16 v[80:95], v[20:23], v[160:163], v[80:95]
    ds_read_b64_tr_b16 v[32:33], v15 offset:43008
    ds_read_b64_tr_b16 v[34:35], v15 offset:43520
    s_waitcnt lgkmcnt(2)
    v_mfma_f32_32x32x16_bf16 v[64:79], v[28:31], v[164:167], v[64:79]
    ds_read_b64_tr_b16 v[16:17], v14 offset:45056
    ds_read_b64_tr_b16 v[18:19], v14 offset:45568
    s_waitcnt lgkmcnt(2)
    v_mfma_f32_32x32x16_bf16 v[80:95], v[32:35], v[164:167], v[80:95]
    ds_read_b64_tr_b16 v[20:21], v15 offset:45056
    ds_read_b64_tr_b16 v[22:23], v15 offset:45568
    s_waitcnt vmcnt(4)
    s_barrier
    s_cmp_eq_u32 s48, 0
    s_cbranch_scc0 L_ok9
    v_readfirstlane_b32 s56, v44
    s_nop 0
    s_cmp_ge_u32 s56, 1
    s_cbranch_scc1 L_ok9
    s_mov_b32 s66, 0
L_poll9:
    buffer_load_dword v44, v47, s[40:43], 0 offen sc1
    s_waitcnt vmcnt(0)
    v_readfirstlane_b32 s56, v44
    s_add_u32 s66, s66, 1
    s_cmp_ge_u32 s66, 0x80000
    s_cbranch_scc1 L_ok9
    s_cmp_lt_u32 s56, 1
    s_cbranch_scc1 L_poll9
L_ok9:
    s_lshl_b32 s56, s50, 8
    v_mov_b32 v45, 0x7fff0000
    v_mov_b32 v116, s56
    v_cmp_eq_u32 vcc, 0, v0
    s_nop 1
    v_cndmask_b32 v45, v45, v116, vcc
    buffer_atomic_add v46, v45, s[32:35], 0 offen sc1
    s_waitcnt lgkmcnt(2)
    v_mfma_f32_32x32x16_bf16 v[64:79], v[16:19], v[168:171], v[64:79]
    ds_read_b64_tr_b16 v[28:29], v14 offset:47104
    ds_read_b64_tr_b16 v[30:31], v14 offset:47616
    s_waitcnt lgkmcnt(2)
    v_mfma_f32_32x32x16_bf16 v[80:95], v[20:23], v[168:171], v[80:95]
    ds_read_b64_tr_b16 v[32:33], v15 offset:47104
    ds_read_b64_tr_b16 v[34:35], v15 offset:47616
    s_waitcnt lgkmcnt(2)
    v_mfma_f32_32x32x16_bf16 v[64:79], v[28:31], v[172:175], v[64:79]
    ds_read_b64_tr_b16 v[16:17], v14 offset:57344
    ds_read_b64_tr_b16 v[18:19], v14 offset:57856
    s_waitcnt lgkmcnt(2)
    v_mfma_f32_32x32x16_bf16 v[80:95], v[32:35], v[172:175], v[80:95]
    ds_read_b64_tr_b16 v[20:21], v15 offset:57344
    ds_read_b64_tr_b16 v[22:23], v15 offset:57856
    s_waitcnt lgkmcnt(2)
    v_mfma_f32_32x32x16_bf16 v[64:79], v[16:19], v[176:179], v[64:79]
    ds_read_b64_tr_b16 v[28:29], v14 offset:59392
    ds_read_b64_tr_b16 v[30:31], v14 offset:59904
    s_waitcnt lgkmcnt(2)
    v_mfma_f32_32x32x16_bf16 v[80:95], v[20:23], v[176:179], v[80:95]
    ds_read_b64_tr_b16 v[32:33], v15 offset:59392
    ds_read_b64_tr_b16 v[34:35], v15 offset:59904
    buffer_store_dword v42, v43, s[32:35], s19 offen sc1
    s_waitcnt lgkmcnt(2)
    v_mfma_f32_32x32x16_bf16 v[64:79], v[28:31], v[180:183], v[64:79]
    ds_read_b64_tr_b16 v[16:17], v14 offset:61440
    ds_read_b64_tr_b16 v[18:19], v14 offset:61952
    s_waitcnt lgkmcnt(2)
    v_mfma_f32_32x32x16_bf16 v[80:95], v[32:35], v[180:183], v[80:95]
    ds_read_b64_tr_b16 v[20:21], v15 offset:61440
    ds_read_b64_tr_b16 v[22:23], v15 offset:61952
    s_barrier
    s_waitcnt lgkmcnt(2)
    v_mfma_f32_32x32x16_bf16 v[64:79], v[16:19], v[184:187], v[64:79]
    ds_read_b64_tr_b16 v[28:29], v14 offset:63488
    ds_read_b64_tr_b16 v[30:31], v14 offset:64000
    s_waitcnt lgkmcnt(2)
    v_mfma_f32_32x32x16_bf16 v[80:95], v[20:23], v[184:187], v[80:95]
    ds_read_b64_tr_b16 v[32:33], v15 offset:63488
    ds_read_b64_tr_b16 v[34:35], v15 offset:64000
    s_waitcnt lgkmcnt(2)
    v_mfma_f32_32x32x16_bf16 v[64:79], v[28:31], v[188:191], v[64:79]
    v_add_u32 v14, 0x14000, v14
    v_add_u32 v15, 0x14000, v15
    ds_read_b64_tr_b16 v[16:17], v14 offset:16384
    ds_read_b64_tr_b16 v[18:19], v14 offset:16896
    s_waitcnt lgkmcnt(2)
    v_mfma_f32_32x32x16_bf16 v[80:95], v[32:35], v[188:191], v[80:95]
    ds_read_b64_tr_b16 v[20:21], v15 offset:16384
    ds_read_b64_tr_b16 v[22:23], v15 offset:16896
    s_waitcnt lgkmcnt(2)
    v_mfma_f32_32x32x16_bf16 v[64:79], v[16:19], v[192:195], v[64:79]
    ds_read_b64_tr_b16 v[28:29], v14 offset:18432
    ds_read_b64_tr_b16 v[30:31], v14 offset:18944
    s_waitcnt lgkmcnt(2)
    v_mfma_f32_32x32x16_bf16 v[80:95], v[20:23], v[192:195], v[80:95]
    ds_read_b64_tr_b16 v[32:33], v15 offset:18432
    ds_read_b64_tr_b16 v[34:35], v15 offset:18944
    s_waitcnt lgkmcnt(2)
    v_mfma_f32_32x32x16_bf16 v[64:79], v[28:31], v[196:199], v[64:79]
    ds_read_b64_tr_b16 v[16:17], v14 offset:20480
    ds_read_b64_tr_b16 v[18:19], v14 offset:20992
    s_waitcnt lgkmcnt(2)
    v_mfma_f32_32x32x16_bf16 v[80:95], v[32:35], v[196:199], v[80:95]
    ds_read_b64_tr_b16 v[20:21], v15 offset:20480
    ds_read_b64_tr_b16 v[22:23], v15 offset:20992
    s_barrier
    s_waitcnt lgkmcnt(2)
    v_mfma_f32_32x32x16_bf16 v[64:79], v[16:19], v[200:203], v[64:79]
    ds_read_b64_tr_b16 v[28:29], v14 offset:22528
    ds_read_b64_tr_b16 v[30:31], v14 offset:23040
    s_waitcnt lgkmcnt(2)
    v_mfma_f32_32x32x16_bf16 v[80:95], v[20:23], v[200:203], v[80:95]
    ds_read_b64_tr_b16 v[32:33], v15 offset:22528
    ds_read_b64_tr_b16 v[34:35], v15 offset:23040
    s_waitcnt lgkmcnt(2)
    v_mfma_f32_32x32x16_bf16 v[64:79], v[28:31], v[204:207], v[64:79]
    ds_read_b64_tr_b16 v[16:17], v14 offset:0
    ds_read_b64_tr_b16 v[18:19], v14 offset:512
    s_waitcnt lgkmcnt(2)
    v_mfma_f32_32x32x16_bf16 v[80:95], v[32:35], v[204:207], v[80:95]
    ds_read_b64_tr_b16 v[20:21], v15 offset:0
    ds_read_b64_tr_b16 v[22:23], v15 offset:512
    s_waitcnt lgkmcnt(2)
    v_mfma_f32_32x32x16_bf16 v[64:79], v[16:19], v[208:211], v[64:79]
    ds_read_b64_tr_b16 v[28:29], v14 offset:2048
    ds_read_b64_tr_b16 v[30:31], v14 offset:2560
    s_waitcnt lgkmcnt(2)
    v_mfma_f32_32x32x16_bf16 v[80:95], v[20:23], v[208:211], v[80:95]
    ds_read_b64_tr_b16 v[32:33], v15 offset:2048
    ds_read_b64_tr_b16 v[34:35], v15 offset:2560
    s_waitcnt lgkmcnt(2)
    v_mfma_f32_32x32x16_bf16 v[64:79], v[28:31], v[212:215], v[64:79]
    ds_read_b64_tr_b16 v[16:17], v14 offset:4096
    ds_read_b64_tr_b16 v[18:19], v14 offset:4608
    s_waitcnt lgkmcnt(2)
    v_mfma_f32_32x32x16_bf16 v[80:95], v[32:35], v[212:215], v[80:95]
    ds_read_b64_tr_b16 v[20:21], v15 offset:4096
    ds_read_b64_tr_b16 v[22:23], v15 offset:4608
    s_waitcnt vmcnt(4)
    s_barrier
    s_lshr_b32 s56, s63, 2
    s_lshl_b32 s56, s56, 8
    v_mov_b32 v45, s56
    buffer_load_dword v44, v45, s[32:35], 0 offen sc1
    v_lshlrev_b32 v3, 4, v2
    s_lshl_b32 s26, s48, 11
    s_lshl_b32 s101, s63, 16
    s_add_u32 s101, s101, s26
    s_waitcnt lgkmcnt(2)
    v_mfma_f32_32x32x16_bf16 v[64:79], v[16:19], v[216:219], v[64:79]
    ds_read_b64_tr_b16 v[28:29], v14 offset:6144
    ds_read_b64_tr_b16 v[30:31], v14 offset:6656
    s_waitcnt lgkmcnt(2)
    v_mfma_f32_32x32x16_bf16 v[80:95], v[20:23], v[216:219], v[80:95]
    ds_read_b64_tr_b16 v[32:33], v15 offset:6144
    ds_read_b64_tr_b16 v[34:35], v15 offset:6656
    s_waitcnt lgkmcnt(2)
    v_mfma_f32_32x32x16_bf16 v[64:79], v[28:31], v[220:223], v[64:79]
    v_add_u32 v14, 0xc000, v14
    v_add_u32 v15, 0xc000, v15
    ds_read_b64_tr_b16 v[16:17], v14 offset:0
    ds_read_b64_tr_b16 v[18:19], v14 offset:512
    s_waitcnt lgkmcnt(2)
    v_mfma_f32_32x32x16_bf16 v[80:95], v[32:35], v[220:223], v[80:95]
    ds_read_b64_tr_b16 v[20:21], v15 offset:0
    ds_read_b64_tr_b16 v[22:23], v15 offset:512
    s_waitcnt lgkmcnt(2)
    v_mfma_f32_32x32x16_bf16 v[64:79], v[16:19], v[224:227], v[64:79]
    ds_read_b64_tr_b16 v[28:29], v14 offset:2048
    ds_read_b64_tr_b16 v[30:31], v14 offset:2560
    s_waitcnt lgkmcnt(2)
    v_mfma_f32_32x32x16_bf16 v[80:95], v[20:23], v[224:227], v[80:95]
    ds_read_b64_tr_b16 v[32:33], v15 offset:2048
    ds_read_b64_tr_b16 v[34:35], v15 offset:2560
    s_waitcnt lgkmcnt(2)
    v_mfma_f32_32x32x16_bf16 v[64:79], v[28:31], v[228:231], v[64:79]
    ds_read_b64_tr_b16 v[16:17], v14 offset:4096
    ds_read_b64_tr_b16 v[18:19], v14 offset:4608
    s_waitcnt lgkmcnt(2)
    v_mfma_f32_32x32x16_bf16 v[80:95], v[32:35], v[228:231], v[80:95]
    ds_read_b64_tr_b16 v[20:21], v15 offset:4096
    ds_read_b64_tr_b16 v[22:23], v15 offset:4608
    s_waitcnt vmcnt(0)
    s_cmp_eq_u32 s48, 0
    s_cbranch_scc0 L_ok10
    v_readfirstlane_b32 s56, v44
    s_nop 0
    s_cmp_ge_u32 s56, 16
    s_cbranch_scc1 L_ok10
    s_mov_b32 s66, 0
L_poll10:
    buffer_load_dword v44, v45, s[32:35], 0 offen sc1
    s_waitcnt vmcnt(0)
    v_readfirstlane_b32 s56, v44
    s_add_u32 s66, s66, 1
    s_cmp_ge_u32 s66, 0x80000
    s_cbranch_scc1 L_ok10
    s_cmp_lt_u32 s56, 16
    s_cbranch_scc1 L_poll10
L_ok10:
    s_barrier
    s_add_u32 m0, s26, 32768
    s_add_u32 s57, s101, 0x400000
    buffer_load_dwordx4 v3, s[32:35], s57 offen sc1 lds
    s_add_u32 m0, s26, 33792
    s_add_u32 s57, s101, 0x400400
    buffer_load_dwordx4 v3, s[32:35], s57 offen sc1 lds
    s_add_u32 m0, s26, 98304
    s_add_u32 s57, s101, 0x600000
    buffer_load_dwordx4 v3, s[32:35], s57 offen sc1 lds
    s_add_u32 m0, s26, 99328
    s_add_u32 s57, s101, 0x600400
    buffer_load_dwordx4 v3, s[32:35], s57 offen sc1 lds
    s_lshl_b32 s56, s64, 3
    s_add_u32 s56, s56, s48
    s_lshl_b32 s57, s63, 6
    s_add_u32 s57, s57, s56
    s_lshl_b32 s58, s57, 10
    s_add_u32 s58, s58, 0x200000
    buffer_load_dwordx4 v[4:7], v13, s[32:35], s58 offen sc1
    s_lshr_b32 s58, s63, 2
    s_lshl_b32 s58, s58, 11
    s_and_b32 s57, s63, 3
    s_lshl_b32 s57, s57, 5
    s_add_u32 s58, s58, s57
    s_add_u32 s58, s58, 0x4000
    v_lshrrev_b32 v100, 2, v2
    v_lshlrev_b32 v100, 7, v100
    v_and_b32 v103, 3, v2
    v_lshl_add_u32 v100, v103, 3, v100
    buffer_load_dword v101, v100, s[32:35], s58 offen offset:4 sc1
    s_lshr_b32 s57, s56, 2
    s_lshl_b32 s57, s57, 7
    s_and_b32 s56, s56, 3
    s_lshl_b32 s56, s56, 3
    s_add_u32 s58, s58, s57
    s_add_u32 s58, s58, s56
    v_mov_b32 v103, 0
    buffer_load_dword v102, v103, s[32:35], s58 offen sc1
    s_add_u32 m0, s26, 49152
    s_add_u32 s57, s101, 0x404000
    buffer_load_dwordx4 v3, s[32:35], s57 offen sc1 lds
    s_waitcnt lgkmcnt(2)
    v_mfma_f32_32x32x16_bf16 v[64:79], v[16:19], v[232:235], v[64:79]
    ds_read_b64_tr_b16 v[28:29], v14 offset:6144
    ds_read_b64_tr_b16 v[30:31], v14 offset:6656
    s_add_u32 m0, s26, 50176
    s_add_u32 s57, s101, 0x404400
    buffer_load_dwordx4 v3, s[32:35], s57 offen sc1 lds
    s_waitcnt lgkmcnt(2)
    v_mfma_f32_32x32x16_bf16 v[80:95], v[20:23], v[232:235], v[80:95]
    ds_read_b64_tr_b16 v[32:33], v15 offset:6144
    ds_read_b64_tr_b16 v[34:35], v15 offset:6656
    s_waitcnt lgkmcnt(2)
    v_mfma_f32_32x32x16_bf16 v[64:79], v[28:31], v[236:239], v[64:79]
    ds_read_b64_tr_b16 v[16:17], v14 offset:16384
    ds_read_b64_tr_b16 v[18:19], v14 offset:16896
    s_add_u32 m0, s26, 114688
    s_add_u32 s57, s101, 0x604000
    buffer_load_dwordx4 v3, s[32:35], s57 offen sc1 lds
    s_waitcnt lgkmcnt(2)
    v_mfma_f32_32x32x16_bf16 v[80:95], v[32:35], v[236:239], v[80:95]
    ds_read_b64_tr_b16 v[20:21], v15 offset:16384
    ds_read_b64_tr_b16 v[22:23], v15 offset:16896
    s_waitcnt lgkmcnt(2)
    v_mfma_f32_32x32x16_bf16 v[64:79], v[16:19], v[240:243], v[64:79]
    ds_read_b64_tr_b16 v[28:29], v14 offset:18432
    ds_read_b64_tr_b16 v[30:31], v14 offset:18944
    s_add_u32 m0, s26, 115712
    s_add_u32 s57, s101, 0x604400
    buffer_load_dwordx4 v3, s[32:35], s57 offen sc1 lds
    s_waitcnt lgkmcnt(2)
    v_mfma_f32_32x32x16_bf16 v[80:95], v[20:23], v[240:243], v[80:95]
    ds_read_b64_tr_b16 v[32:33], v15 offset:18432
    ds_read_b64_tr_b16 v[34:35], v15 offset:18944
    s_waitcnt lgkmcnt(2)
    v_mfma_f32_32x32x16_bf16 v[64:79], v[28:31], v[244:247], v[64:79]
    ds_read_b64_tr_b16 v[16:17], v14 offset:20480
    ds_read_b64_tr_b16 v[18:19], v14 offset:20992
    s_waitcnt lgkmcnt(2)
    v_mfma_f32_32x32x16_bf16 v[80:95], v[32:35], v[244:247], v[80:95]
    ds_read_b64_tr_b16 v[20:21], v15 offset:20480
    ds_read_b64_tr_b16 v[22:23], v15 offset:20992
    s_barrier
    s_waitcnt lgkmcnt(2)
    v_mfma_f32_32x32x16_bf16 v[64:79], v[16:19], v[248:251], v[64:79]
    ds_read_b64_tr_b16 v[28:29], v14 offset:22528
    ds_read_b64_tr_b16 v[30:31], v14 offset:23040
    s_waitcnt lgkmcnt(2)
    v_mfma_f32_32x32x16_bf16 v[80:95], v[20:23], v[248:251], v[80:95]
    ds_read_b64_tr_b16 v[32:33], v15 offset:22528
    ds_read_b64_tr_b16 v[34:35], v15 offset:23040
    s_waitcnt lgkmcnt(2)
    v_mfma_f32_32x32x16_bf16 v[64:79], v[28:31], v[252:255], v[64:79]
    s_waitcnt lgkmcnt(0)
    v_mfma_f32_32x32x16_bf16 v[80:95], v[32:35], v[252:255], v[80:95]
    s_lshr_b32 s58, s27, 5
    s_lshl_b32 s56, s52, 1
    s_add_u32 s56, s56, s58
    s_mul_i32 s57, s53, 112
    s_add_u32 s68, s56, s57
    s_lshl_b32 s18, s68, 10
    s_nop 3
    v_max_f32 v64, 0, v64
    v_max_f32 v65, 0, v65
    v_max_f32 v66, 0, v66
    v_max_f32 v67, 0, v67
    v_max_f32 v68, 0, v68
    v_max_f32 v69, 0, v69
    v_max_f32 v70, 0, v70
    v_max_f32 v71, 0, v71
    v_mul_f32 v64, v64, v72
    v_mul_f32 v65, v65, v73
    v_mul_f32 v66, v66, v74
    v_mul_f32 v67, v67, v75
    v_mul_f32 v68, v68, v76
    v_mul_f32 v69, v69, v77
    v_mul_f32 v70, v70, v78
    v_mul_f32 v71, v71, v79
    v_cvt_pk_bf16_f32 v128, v64, v65
    v_cvt_pk_bf16_f32 v129, v66, v67
    v_cvt_pk_bf16_f32 v130, v68, v69
    v_cvt_pk_bf16_f32 v131, v70, v71
    v_max_f32 v80, 0, v80
    v_max_f32 v81, 0, v81
    v_max_f32 v82, 0, v82
    v_max_f32 v83, 0, v83
    v_max_f32 v84, 0, v84
    v_max_f32 v85, 0, v85
    v_max_f32 v86, 0, v86
    v_max_f32 v87, 0, v87
    v_mul_f32 v80, v80, v88
    v_mul_f32 v81, v81, v89
    v_mul_f32 v82, v82, v90
    v_mul_f32 v83, v83, v91
    v_mul_f32 v84, v84, v92
    v_mul_f32 v85, v85, v93
    v_mul_f32 v86, v86, v94
    v_mul_f32 v87, v87, v95
    v_cvt_pk_bf16_f32 v132, v80, v81
    v_cvt_pk_bf16_f32 v133, v82, v83
    v_cvt_pk_bf16_f32 v134, v84, v85
    v_cvt_pk_bf16_f32 v135, v86, v87
    s_branch L_p1_join
L_p1_B:
    ds_read_b128 v[128:131], v40 offset:0
    ds_read_b64_tr_b16 v[16:17], v10 offset:0
    ds_read_b64_tr_b16 v[18:19], v10 offset:768
    ds_read_b64_tr_b16 v[20:21], v11 offset:32
    ds_read_b64_tr_b16 v[22:23], v11 offset:800
    ds_read_b64_tr_b16 v[24:25], v12 offset:64
    ds_read_b64_tr_b16 v[26:27], v12 offset:832
    s_waitcnt lgkmcnt(4)
    v_mfma_f32_32x32x16_bf16 v[64:79], v[16:19], v[128:131], 0
    ds_read_b128 v[132:135], v41 offset:0
    ds_read_b64_tr_b16 v[28:29], v10 offset:3072
    ds_read_b64_tr_b16 v[30:31], v10 offset:3840
    s_add_u32 m0, s10, 81920
    s_movk_i32 s57, 256
    buffer_load_dwordx4 v3, s[28:31], s57 offen lds
    s_waitcnt lgkmcnt(5)
    v_mfma_f32_32x32x16_bf16 v[80:95], v[20:23], v[128:131], 0
    ds_read_b64_tr_b16 v[32:33], v11 offset:3104
    ds_read_b64_tr_b16 v[34:35], v11 offset:3872
    s_add_u32 m0, s10, 82944
    s_movk_i32 s57, 256
    buffer_load_dwordx4 v4, s[28:31], s57 offen lds
    s_waitcnt lgkmcnt(5)
    v_mfma_f32_32x32x16_bf16 v[96:111], v[24:27], v[128:131], 0
    ds_read_b64_tr_b16 v[36:37], v12 offset:3136
    ds_read_b64_tr_b16 v[38:39], v12 offset:3904
    s_waitcnt lgkmcnt(4)
    v_mfma_f32_32x32x16_bf16 v[64:79], v[28:31], v[132:135], v[64:79]
    ds_read_b128 v[136:139], v42 offset:0
    ds_read_b64_tr_b16 v[16:17], v10 offset:6144
    ds_read_b64_tr_b16 v[18:19], v10 offset:6912
    s_add_u32 m0, s11, 81920
    s_add_u32 s100, s100, s62
    buffer_load_dwordx4 v5, s[96:99], s100 offen lds
    s_waitcnt lgkmcnt(5)
    v_mfma_f32_32x32x16_bf16 v[80:95], v[32:35], v[132:135], v[80:95]
    ds_read_b64_tr_b16 v[20:21], v11 offset:6176
    ds_read_b64_tr_b16 v[22:23], v11 offset:6944
    s_add_u32 m0, s0, 81920
    s_nop 0
    buffer_load_dwordx4 v6, s[96:99], s100 offen lds
    s_waitcnt lgkmcnt(5)
    v_mfma_f32_32x32x16_bf16 v[96:111], v[36:39], v[132:135], v[96:111]
    ds_read_b64_tr_b16 v[24:25], v12 offset:6208
    ds_read_b64_tr_b16 v[26:27], v12 offset:6976
    s_waitcnt vmcnt(7)
    s_barrier
    s_waitcnt lgkmcnt(4)
    v_mfma_f32_32x32x16_bf16 v[64:79], v[16:19], v[136:139], v[64:79]
    ds_read_b128 v[140:143], v43 offset:0
    ds_read_b64_tr_b16 v[28:29], v10 offset:9216
    ds_read_b64_tr_b16 v[30:31], v10 offset:9984
    s_add_u32 m0, s1, 81920
    s_nop 0
    buffer_load_dwordx4 v7, s[96:99], s100 offen lds
    s_waitcnt lgkmcnt(5)
    v_mfma_f32_32x32x16_bf16 v[80:95], v[20:23], v[136:139], v[80:95]
    ds_read_b64_tr_b16 v[32:33], v11 offset:9248
    ds_read_b64_tr_b16 v[34:35], v11 offset:10016
    s_add_u32 m0, s10, 122880
    s_movk_i32 s57, 384
    buffer_load_dwordx4 v3, s[28:31], s57 offen lds
    s_waitcnt lgkmcnt(5)
    v_mfma_f32_32x32x16_bf16 v[96:111], v[24:27], v[136:139], v[96:111]
    ds_read_b64_tr_b16 v[36:37], v12 offset:9280
    ds_read_b64_tr_b16 v[38:39], v12 offset:10048
    s_waitcnt lgkmcnt(4)
    v_mfma_f32_32x32x16_bf16 v[64:79], v[28:31], v[140:143], v[64:79]
    ds_read_b128 v[144:147], v40 offset:40960
    ds_read_b64_tr_b16 v[16:17], v10 offset:40960
    ds_read_b64_tr_b16 v[18:19], v10 offset:41728
    s_add_u32 m0, s10, 123904
    s_movk_i32 s57, 384
    buffer_load_dwordx4 v4, s[28:31], s57 offen lds
    s_waitcnt lgkmcnt(5)
    v_mfma_f32_32x32x16_bf16 v[80:95], v[32:35], v[140:143], v[80:95]
    ds_read_b64_tr_b16 v[20:21], v11 offset:40992
    ds_read_b64_tr_b16 v[22:23], v11 offset:41760
    s_add_u32 m0, s11, 122880
    s_add_u32 s100, s100, s62
    buffer_load_dwordx4 v5, s[96:99], s100 offen lds
    s_waitcnt lgkmcnt(5)
    v_mfma_f32_32x32x16_bf16 v[96:111], v[36:39], v[140:143], v[96:111]
    ds_read_b64_tr_b16 v[24:25], v12 offset:41024
    ds_read_b64_tr_b16 v[26:27], v12 offset:41792
    s_waitcnt lgkmcnt(4)
    v_mfma_f32_32x32x16_bf16 v[64:79], v[16:19], v[144:147], v[64:79]
    ds_read_b128 v[148:151], v41 offset:40960
    ds_read_b64_tr_b16 v[28:29], v10 offset:44032
    ds_read_b64_tr_b16 v[30:31], v10 offset:44800
    s_add_u32 m0, s0, 122880
    s_nop 0
    buffer_load_dwordx4 v6, s[96:99], s100 offen lds
    s_waitcnt lgkmcnt(5)
    v_mfma_f32_32x32x16_bf16 v[80:95], v[20:23], v[144:147], v[80:95]
    ds_read_b64_tr_b16 v[32:33], v11 offset:44064
    ds_read_b64_tr_b16 v[34:35], v11 offset:44832
    s_add_u32 m0, s1, 122880
    s_nop 0
    buffer_load_dwordx4 v7, s[96:99], s100 offen lds
    s_waitcnt lgkmcnt(5)
    v_mfma_f32_32x32x16_bf16 v[96:111], v[24:27], v[144:147], v[96:111]
    ds_read_b64_tr_b16 v[36:37], v12 offset:44096
    ds_read_b64_tr_b16 v[38:39], v12 offset:44864
    s_waitcnt lgkmcnt(4)
    v_mfma_f32_32x32x16_bf16 v[64:79], v[28:31], v[148:151], v[64:79]
    ds_read_b128 v[152:155], v42 offset:40960
    ds_read_b64_tr_b16 v[16:17], v10 offset:47104
    ds_read_b64_tr_b16 v[18:19], v10 offset:47872
    s_waitcnt lgkmcnt(5)
    v_mfma_f32_32x32x16_bf16 v[80:95], v[32:35], v[148:151], v[80:95]
    ds_read_b64_tr_b16 v[20:21], v11 offset:47136
    ds_read_b64_tr_b16 v[22:23], v11 offset:47904
    s_waitcnt lgkmcnt(5)
    v_mfma_f32_32x32x16_bf16 v[96:111], v[36:39], v[148:151], v[96:111]
    ds_read_b64_tr_b16 v[24:25], v12 offset:47168
    ds_read_b64_tr_b16 v[26:27], v12 offset:47936
    s_waitcnt vmcnt(5)
    s_barrier
    s_waitcnt lgkmcnt(4)
    v_mfma_f32_32x32x16_bf16 v[64:79], v[16:19], v[152:155], v[64:79]
    ds_read_b128 v[156:159], v43 offset:40960
    ds_read_b64_tr_b16 v[28:29], v10 offset:50176
    ds_read_b64_tr_b16 v[30:31], v10 offset:50944
    s_add_u32 m0, s10, 0
    s_movk_i32 s57, 512
    buffer_load_dwordx4 v3, s[28:31], s57 offen lds
    s_waitcnt lgkmcnt(5)
    v_mfma_f32_32x32x16_bf16 v[80:95], v[20:23], v[152:155], v[80:95]
    ds_read_b64_tr_b16 v[32:33], v11 offset:50208
    ds_read_b64_tr_b16 v[34:35], v11 offset:50976
    s_add_u32 m0, s10, 1024
    s_movk_i32 s57, 512
    buffer_load_dwordx4 v4, s[28:31], s57 offen lds
    s_waitcnt lgkmcnt(5)
    v_mfma_f32_32x32x16_bf16 v[96:111], v[24:27], v[152:155], v[96:111]
    ds_read_b64_tr_b16 v[36:37], v12 offset:50240
    ds_read_b64_tr_b16 v[38:39], v12 offset:51008
    s_waitcnt lgkmcnt(4)
    v_mfma_f32_32x32x16_bf16 v[64:79], v[28:31], v[156:159], v[64:79]
    v_add_u32 v40, 0x14000, v40
    v_add_u32 v41, 0x14000, v41
    v_add_u32 v42, 0x14000, v42
    v_add_u32 v43, 0x14000, v43
    v_add_u32 v10, 0x14000, v10
    v_add_u32 v11, 0x14000, v11
    v_add_u32 v12, 0x14000, v12
    ds_read_b128 v[160:163], v40 offset:0
    ds_read_b64_tr_b16 v[16:17], v10 offset:0
    ds_read_b64_tr_b16 v[18:19], v10 offset:768
    s_add_u32 m0, s11, 0
    s_add_u32 s100, s100, s62
    buffer_load_dwordx4 v5, s[96:99], s100 offen lds
    s_waitcnt lgkmcnt(5)
    v_mfma_f32_32x32x16_bf16 v[80:95], v[32:35], v[156:159], v[80:95]
    ds_read_b64_tr_b16 v[20:21], v11 offset:32
    ds_read_b64_tr_b16 v[22:23], v11 offset:800
    s_add_u32 m0, s0, 0
    s_nop 0
    buffer_load_dwordx4 v6, s[96:99], s100 offen lds
    s_waitcnt lgkmcnt(5)
    v_mfma_f32_32x32x16_bf16 v[96:111], v[36:39], v[156:159], v[96:111]
    ds_read_b64_tr_b16 v[24:25], v12 offset:64
    ds_read_b64_tr_b16 v[26:27], v12 offset:832
    s_waitcnt lgkmcnt(4)
    v_mfma_f32_32x32x16_bf16 v[64:79], v[16:19], v[160:163], v[64:79]
    ds_read_b128 v[164:167], v41 offset:0
    ds_read_b64_tr_b16 v[28:29], v10 offset:3072
    ds_read_b64_tr_b16 v[30:31], v10 offset:3840
    s_add_u32 m0, s1, 0
    s_nop 0
    buffer_load_dwordx4 v7, s[96:99], s100 offen lds
    s_waitcnt lgkmcnt(5)
    v_mfma_f32_32x32x16_bf16 v[80:95], v[20:23], v[160:163], v[80:95]
    ds_read_b64_tr_b16 v[32:33], v11 offset:3104
    ds_read_b64_tr_b16 v[34:35], v11 offset:3872
    s_waitcnt lgkmcnt(5)
    v_mfma_f32_32x32x16_bf16 v[96:111], v[24:27], v[160:163], v[96:111]
    ds_read_b64_tr_b16 v[36:37], v12 offset:3136
    ds_read_b64_tr_b16 v[38:39], v12 offset:3904
    s_waitcnt lgkmcnt(4)
    v_mfma_f32_32x32x16_bf16 v[64:79], v[28:31], v[164:167], v[64:79]
    ds_read_b128 v[168:171], v42 offset:0
    ds_read_b64_tr_b16 v[16:17], v10 offset:6144
    ds_read_b64_tr_b16 v[18:19], v10 offset:6912
    s_waitcnt lgkmcnt(5)
    v_mfma_f32_32x32x16_bf16 v[80:95], v[32:35], v[164:167], v[80:95]
    ds_read_b64_tr_b16 v[20:21], v11 offset:6176
    ds_read_b64_tr_b16 v[22:23], v11 offset:6944
    s_waitcnt lgkmcnt(5)
    v_mfma_f32_32x32x16_bf16 v[96:111], v[36:39], v[164:167], v[96:111]
    ds_read_b64_tr_b16 v[24:25], v12 offset:6208
    ds_read_b64_tr_b16 v[26:27], v12 offset:6976
    s_waitcnt vmcnt(5)
    s_barrier
    buffer_load_dword v44, v47, s[40:43], 0 offen sc1
    s_waitcnt lgkmcnt(4)
    v_mfma_f32_32x32x16_bf16 v[64:79], v[16:19], v[168:171], v[64:79]
    ds_read_b128 v[172:175], v43 offset:0
    ds_read_b64_tr_b16 v[28:29], v10 offset:9216
    ds_read_b64_tr_b16 v[30:31], v10 offset:9984
    s_add_u32 m0, s10, 40960
    s_movk_i32 s57, 640
    buffer_load_dwordx4 v3, s[28:31], s57 offen lds
    s_waitcnt lgkmcnt(5)
    v_mfma_f32_32x32x16_bf16 v[80:95], v[20:23], v[168:171], v[80:95]
    ds_read_b64_tr_b16 v[32:33], v11 offset:9248
    ds_read_b64_tr_b16 v[34:35], v11 offset:10016
    s_add_u32 m0, s10, 41984
    s_movk_i32 s57, 640
    buffer_load_dwordx4 v4, s[28:31], s57 offen lds
    s_waitcnt lgkmcnt(5)
    v_mfma_f32_32x32x16_bf16 v[96:111], v[24:27], v[168:171], v[96:111]
    ds_read_b64_tr_b16 v[36:37], v12 offset:9280
    ds_read_b64_tr_b16 v[38:39], v12 offset:10048
    s_waitcnt lgkmcnt(4)
    v_mfma_f32_32x32x16_bf16 v[64:79], v[28:31], v[172:175], v[64:79]
    ds_read_b128 v[176:179], v40 offset:40960
    ds_read_b64_tr_b16 v[16:17], v10 offset:40960
    ds_read_b64_tr_b16 v[18:19], v10 offset:41728
    s_add_u32 m0, s11, 40960
    s_add_u32 s100, s100, s62
    buffer_load_dwordx4 v5, s[96:99], s100 offen lds
    s_waitcnt lgkmcnt(5)
    v_mfma_f32_32x32x16_bf16 v[80:95], v[32:35], v[172:175], v[80:95]
    ds_read_b64_tr_b16 v[20:21], v11 offset:40992
    ds_read_b64_tr_b16 v[22:23], v11 offset:41760
    s_add_u32 m0, s0, 40960
    s_nop 0
    buffer_load_dwordx4 v6, s[96:99], s100 offen lds
    s_waitcnt lgkmcnt(5)
    v_mfma_f32_32x32x16_bf16 v[96:111], v[36:39], v[172:175], v[96:111]
    ds_read_b64_tr_b16 v[24:25], v12 offset:41024
    ds_read_b64_tr_b16 v[26:27], v12 offset:41792
    s_waitcnt lgkmcnt(4)
    v_mfma_f32_32x32x16_bf16 v[64:79], v[16:19], v[176:179], v[64:79]
    ds_read_b128 v[180:183], v41 offset:40960
    ds_read_b64_tr_b16 v[28:29], v10 offset:44032
    ds_read_b64_tr_b16 v[30:31], v10 offset:44800
    s_add_u32 m0, s1, 40960
    s_nop 0
    buffer_load_dwordx4 v7, s[96:99], s100 offen lds
    s_waitcnt lgkmcnt(5)
    v_mfma_f32_32x32x16_bf16 v[80:95], v[20:23], v[176:179], v[80:95]
    ds_read_b64_tr_b16 v[32:33], v11 offset:44064
    ds_read_b64_tr_b16 v[34:35], v11 offset:44832
    s_waitcnt lgkmcnt(5)
    v_mfma_f32_32x32x16_bf16 v[96:111], v[24:27], v[176:179], v[96:111]
    ds_read_b64_tr_b16 v[36:37], v12 offset:44096
    ds_read_b64_tr_b16 v[38:39], v12 offset:44864
    s_waitcnt lgkmcnt(4)
    v_mfma_f32_32x32x16_bf16 v[64:79], v[28:31], v[180:183], v[64:79]
    ds_read_b128 v[184:187], v42 offset:40960
    ds_read_b64_tr_b16 v[16:17], v10 offset:47104
    ds_read_b64_tr_b16 v[18:19], v10 offset:47872
    s_waitcnt lgkmcnt(5)
    v_mfma_f32_32x32x16_bf16 v[80:95], v[32:35], v[180:183], v[80:95]
    ds_read_b64_tr_b16 v[20:21], v11 offset:47136
    ds_read_b64_tr_b16 v[22:23], v11 offset:47904
    s_waitcnt lgkmcnt(5)
    v_mfma_f32_32x32x16_bf16 v[96:111], v[36:39], v[180:183], v[96:111]
    ds_read_b64_tr_b16 v[24:25], v12 offset:47168
    ds_read_b64_tr_b16 v[26:27], v12 offset:47936
    s_waitcnt vmcnt(6)
    s_barrier
    s_waitcnt lgkmcnt(4)
    v_mfma_f32_32x32x16_bf16 v[64:79], v[16:19], v[184:187], v[64:79]
    ds_read_b128 v[188:191], v43 offset:40960
    ds_read_b64_tr_b16 v[28:29], v10 offset:50176
    ds_read_b64_tr_b16 v[30:31], v10 offset:50944
    s_add_u32 m0, s10, 81920
    s_movk_i32 s57, 768
    buffer_load_dwordx4 v3, s[28:31], s57 offen lds
    s_waitcnt lgkmcnt(5)
    v_mfma_f32_32x32x16_bf16 v[80:95], v[20:23], v[184:187], v[80:95]
    ds_read_b64_tr_b16 v[32:33], v11 offset:50208
    ds_read_b64_tr_b16 v[34:35], v11 offset:50976
    s_add_u32 m0, s10, 82944
    s_movk_i32 s57, 768
    buffer_load_dwordx4 v4, s[28:31], s57 offen lds
    s_waitcnt lgkmcnt(5)
    v_mfma_f32_32x32x16_bf16 v[96:111], v[24:27], v[184:187], v[96:111]
    ds_read_b64_tr_b16 v[36:37], v12 offset:50240
    ds_read_b64_tr_b16 v[38:39], v12 offset:51008
    s_waitcnt lgkmcnt(4)
    v_mfma_f32_32x32x16_bf16 v[64:79], v[28:31], v[188:191], v[64:79]
    v_subrev_u32 v40, 0x14000, v40
    v_subrev_u32 v41, 0x14000, v41
    v_subrev_u32 v42, 0x14000, v42
    v_subrev_u32 v43, 0x14000, v43
    v_subrev_u32 v10, 0x14000, v10
    v_subrev_u32 v11, 0x14000, v11
    v_subrev_u32 v12, 0x14000, v12
    ds_read_b128 v[192:195], v40 offset:0
    ds_read_b64_tr_b16 v[16:17], v10 offset:0
    ds_read_b64_tr_b16 v[18:19], v10 offset:768
    s_add_u32 m0, s11, 81920
    s_add_u32 s100, s100, s62
    buffer_load_dwordx4 v5, s[96:99], s100 offen lds
    s_waitcnt lgkmcnt(5)
    v_mfma_f32_32x32x16_bf16 v[80:95], v[32:35], v[188:191], v[80:95]
    ds_read_b64_tr_b16 v[20:21], v11 offset:32
    ds_read_b64_tr_b16 v[22:23], v11 offset:800
    s_add_u32 m0, s0, 81920
    s_nop 0
    buffer_load_dwordx4 v6, s[96:99], s100 offen lds
    s_waitcnt lgkmcnt(5)
    v_mfma_f32_32x32x16_bf16 v[96:111], v[36:39], v[188:191], v[96:111]
    ds_read_b64_tr_b16 v[24:25], v12 offset:64
    ds_read_b64_tr_b16 v[26:27], v12 offset:832
    s_waitcnt lgkmcnt(4)
    v_mfma_f32_32x32x16_bf16 v[64:79], v[16:19], v[192:195], v[64:79]
    ds_read_b128 v[196:199], v41 offset:0
    ds_read_b64_tr_b16 v[28:29], v10 offset:3072
    ds_read_b64_tr_b16 v[30:31], v10 offset:3840
    s_add_u32 m0, s1, 81920
    s_nop 0
    buffer_load_dwordx4 v7, s[96:99], s100 offen lds
    s_waitcnt lgkmcnt(5)
    v_mfma_f32_32x32x16_bf16 v[80:95], v[20:23], v[192:195], v[80:95]
    ds_read_b64_tr_b16 v[32:33], v11 offset:3104
    ds_read_b64_tr_b16 v[34:35], v11 offset:3872
    s_waitcnt lgkmcnt(5)
    v_mfma_f32_32x32x16_bf16 v[96:111], v[24:27], v[192:195], v[96:111]
    ds_read_b64_tr_b16 v[36:37], v12 offset:3136
    ds_read_b64_tr_b16 v[38:39], v12 offset:3904
    s_waitcnt lgkmcnt(4)
    v_mfma_f32_32x32x16_bf16 v[64:79], v[28:31], v[196:199], v[64:79]
    ds_read_b128 v[200:203], v42 offset:0
    ds_read_b64_tr_b16 v[16:17], v10 offset:6144
    ds_read_b64_tr_b16 v[18:19], v10 offset:6912
    s_waitcnt lgkmcnt(5)
    v_mfma_f32_32x32x16_bf16 v[80:95], v[32:35], v[196:199], v[80:95]
    ds_read_b64_tr_b16 v[20:21], v11 offset:6176
    ds_read_b64_tr_b16 v[22:23], v11 offset:6944
    s_waitcnt lgkmcnt(5)
    v_mfma_f32_32x32x16_bf16 v[96:111], v[36:39], v[196:199], v[96:111]
    ds_read_b64_tr_b16 v[24:25], v12 offset:6208
    ds_read_b64_tr_b16 v[26:27], v12 offset:6976
    s_waitcnt vmcnt(5)
    s_barrier
    v_readfirstlane_b32 s59, v44
    s_getreg_b32 s56, hwreg(HW_REG_XCC_ID, 0, 4)
    s_mul_i32 s57, s56, s56
    s_lshl_b32 s57, s57, 16
    s_lshl_b32 s58, s56, 8
    s_add_u32 s57, s57, s58
    s_add_u32 s57, s57, 1
    s_lshl_b32 s23, s57, 5
    s_add_u32 s58, s54, 48
    s_lshl_b32 s58, s58, 8
    s_cmp_ge_u32 s59, 1
    s_cselect_b32 s58, s58, 0x7fff0000
    s_cselect_b32 s12, 1, 0
    v_mov_b32 v48, 0x7fff0000
    v_mov_b32 v49, s58
    v_cmp_eq_u32 vcc, 0, v0
    s_nop 1
    v_cndmask_b32 v48, v48, v49, vcc
    v_mov_b32 v49, s57
    buffer_atomic_add v49, v48, s[32:35], 0 offen sc1
    s_waitcnt lgkmcnt(4)
    v_mfma_f32_32x32x16_bf16 v[64:79], v[16:19], v[200:203], v[64:79]
    ds_read_b128 v[204:207], v43 offset:0
    ds_read_b64_tr_b16 v[28:29], v10 offset:9216
    ds_read_b64_tr_b16 v[30:31], v10 offset:9984
    s_add_u32 m0, s10, 122880
    s_movk_i32 s57, 896
    buffer_load_dwordx4 v3, s[28:31], s57 offen lds
    s_waitcnt lgkmcnt(5)
    v_mfma_f32_32x32x16_bf16 v[80:95], v[20:23], v[200:203], v[80:95]
    ds_read_b64_tr_b16 v[32:33], v11 offset:9248
    ds_read_b64_tr_b16 v[34:35], v11 offset:10016
    s_add_u32 m0, s10, 123904
    s_movk_i32 s57, 896
    buffer_load_dwordx4 v4, s[28:31], s57 offen lds
    s_waitcnt lgkmcnt(5)
    v_mfma_f32_32x32x16_bf16 v[96:111], v[24:27], v[200:203], v[96:111]
    ds_read_b64_tr_b16 v[36:37], v12 offset:9280
    ds_read_b64_tr_b16 v[38:39], v12 offset:10048
    s_waitcnt lgkmcnt(4)
    v_mfma_f32_32x32x16_bf16 v[64:79], v[28:31], v[204:207], v[64:79]
    ds_read_b128 v[208:211], v40 offset:40960
    ds_read_b64_tr_b16 v[16:17], v10 offset:40960
    ds_read_b64_tr_b16 v[18:19], v10 offset:41728
    s_add_u32 m0, s11, 122880
    s_add_u32 s100, s100, s62
    buffer_load_dwordx4 v5, s[96:99], s100 offen lds
    s_waitcnt lgkmcnt(5)
    v_mfma_f32_32x32x16_bf16 v[80:95], v[32:35], v[204:207], v[80:95]
    ds_read_b64_tr_b16 v[20:21], v11 offset:40992
    ds_read_b64_tr_b16 v[22:23], v11 offset:41760
    s_add_u32 m0, s0, 122880
    s_nop 0
    buffer_load_dwordx4 v6, s[96:99], s100 offen lds
    s_waitcnt lgkmcnt(5)
    v_mfma_f32_32x32x16_bf16 v[96:111], v[36:39], v[204:207], v[96:111]
    ds_read_b64_tr_b16 v[24:25], v12 offset:41024
    ds_read_b64_tr_b16 v[26:27], v12 offset:41792
    s_waitcnt lgkmcnt(4)
    v_mfma_f32_32x32x16_bf16 v[64:79], v[16:19], v[208:211], v[64:79]
    ds_read_b128 v[212:215], v41 offset:40960
    ds_read_b64_tr_b16 v[28:29], v10 offset:44032
    ds_read_b64_tr_b16 v[30:31], v10 offset:44800
    s_add_u32 m0, s1, 122880
    s_nop 0
    buffer_load_dwordx4 v7, s[96:99], s100 offen lds
    s_waitcnt lgkmcnt(5)
    v_mfma_f32_32x32x16_bf16 v[80:95], v[20:23], v[208:211], v[80:95]
    ds_read_b64_tr_b16 v[32:33], v11 offset:44064
    ds_read_b64_tr_b16 v[34:35], v11 offset:44832
    s_waitcnt lgkmcnt(5)
    v_mfma_f32_32x32x16_bf16 v[96:111], v[24:27], v[208:211], v[96:111]
    ds_read_b64_tr_b16 v[36:37], v12 offset:44096
    ds_read_b64_tr_b16 v[38:39], v12 offset:44864
    s_waitcnt lgkmcnt(4)
    v_mfma_f32_32x32x16_bf16 v[64:79], v[28:31], v[212:215], v[64:79]
    ds_read_b128 v[216:219], v42 offset:40960
    ds_read_b64_tr_b16 v[16:17], v10 offset:47104
    ds_read_b64_tr_b16 v[18:19], v10 offset:47872
    s_waitcnt lgkmcnt(5)
    v_mfma_f32_32x32x16_bf16 v[80:95], v[32:35], v[212:215], v[80:95]
    ds_read_b64_tr_b16 v[20:21], v11 offset:47136
    ds_read_b64_tr_b16 v[22:23], v11 offset:47904
    s_waitcnt lgkmcnt(5)
    v_mfma_f32_32x32x16_bf16 v[96:111], v[36:39], v[212:215], v[96:111]
    ds_read_b64_tr_b16 v[24:25], v12 offset:47168
    ds_read_b64_tr_b16 v[26:27], v12 offset:47936
    s_waitcnt vmcnt(6)
    s_barrier
    s_waitcnt lgkmcnt(4)
    v_mfma_f32_32x32x16_bf16 v[64:79], v[16:19], v[216:219], v[64:79]
    ds_read_b128 v[220:223], v43 offset:40960
    ds_read_b64_tr_b16 v[28:29], v10 offset:50176
    ds_read_b64_tr_b16 v[30:31], v10 offset:50944
    s_add_u32 m0, s26, 0
    s_mov_b32 s57, 0
    buffer_load_dwordx4 v8, s[36:39], s57 offen lds
    s_waitcnt lgkmcnt(5)
    v_mfma_f32_32x32x16_bf16 v[80:95], v[20:23], v[216:219], v[80:95]
    ds_read_b64_tr_b16 v[32:33], v11 offset:50208
    ds_read_b64_tr_b16 v[34:35], v11 offset:50976
    s_add_u32 m0, s26, 8192
    s_mov_b32 s57, 0
    buffer_load_dwordx4 v9, s[4:7], s57 offen lds
    s_waitcnt lgkmcnt(5)
    v_mfma_f32_32x32x16_bf16 v[96:111], v[24:27], v[216:219], v[96:111]
    ds_read_b64_tr_b16 v[36:37], v12 offset:50240
    ds_read_b64_tr_b16 v[38:39], v12 offset:51008
    s_waitcnt lgkmcnt(4)
    v_mfma_f32_32x32x16_bf16 v[64:79], v[28:31], v[220:223], v[64:79]
    v_add_u32 v40, 0x14000, v40
    v_add_u32 v41, 0x14000, v41
    v_add_u32 v42, 0x14000, v42
    v_add_u32 v43, 0x14000, v43
    v_add_u32 v10, 0x14000, v10
    v_add_u32 v11, 0x14000, v11
    v_add_u32 v12, 0x14000, v12
    ds_read_b128 v[224:227], v40 offset:0
    ds_read_b64_tr_b16 v[16:17], v10 offset:0
    ds_read_b64_tr_b16 v[18:19], v10 offset:768
    s_add_u32 m0, s26, 16384
    s_mov_b32 s57, 229376
    buffer_load_dwordx4 v8, s[36:39], s57 offen lds
    s_waitcnt lgkmcnt(5)
    v_mfma_f32_32x32x16_bf16 v[80:95], v[32:35], v[220:223], v[80:95]
    ds_read_b64_tr_b16 v[20:21], v11 offset:32
    ds_read_b64_tr_b16 v[22:23], v11 offset:800
    s_add_u32 m0, s26, 24576
    s_mov_b32 s57, 229376
    buffer_load_dwordx4 v9, s[4:7], s57 offen lds
    s_waitcnt lgkmcnt(5)
    v_mfma_f32_32x32x16_bf16 v[96:111], v[36:39], v[220:223], v[96:111]
    ds_read_b64_tr_b16 v[24:25], v12 offset:64
    ds_read_b64_tr_b16 v[26:27], v12 offset:832
    s_waitcnt lgkmcnt(4)
    v_mfma_f32_32x32x16_bf16 v[64:79], v[16:19], v[224:227], v[64:79]
    ds_read_b128 v[228:231], v41 offset:0
    ds_read_b64_tr_b16 v[28:29], v10 offset:3072
    ds_read_b64_tr_b16 v[30:31], v10 offset:3840
    s_waitcnt lgkmcnt(5)
    v_mfma_f32_32x32x16_bf16 v[80:95], v[20:23], v[224:227], v[80:95]
    ds_read_b64_tr_b16 v[32:33], v11 offset:3104
    ds_read_b64_tr_b16 v[34:35], v11 offset:3872
    s_waitcnt lgkmcnt(5)
    v_mfma_f32_32x32x16_bf16 v[96:111], v[24:27], v[224:227], v[96:111]
    ds_read_b64_tr_b16 v[36:37], v12 offset:3136
    ds_read_b64_tr_b16 v[38:39], v12 offset:3904
    s_waitcnt lgkmcnt(4)
    v_mfma_f32_32x32x16_bf16 v[64:79], v[28:31], v[228:231], v[64:79]
    ds_read_b128 v[232:235], v42 offset:0
    ds_read_b64_tr_b16 v[16:17], v10 offset:6144
    ds_read_b64_tr_b16 v[18:19], v10 offset:6912
    s_waitcnt lgkmcnt(5)
    v_mfma_f32_32x32x16_bf16 v[80:95], v[32:35], v[228:231], v[80:95]
    ds_read_b64_tr_b16 v[20:21], v11 offset:6176
    ds_read_b64_tr_b16 v[22:23], v11 offset:6944
    s_waitcnt lgkmcnt(5)
    v_mfma_f32_32x32x16_bf16 v[96:111], v[36:39], v[228:231], v[96:111]
    ds_read_b64_tr_b16 v[24:25], v12 offset:6208
    ds_read_b64_tr_b16 v[26:27], v12 offset:6976
    s_waitcnt vmcnt(4)
    s_barrier
    s_waitcnt lgkmcnt(4)
    v_mfma_f32_32x32x16_bf16 v[64:79], v[16:19], v[232:235], v[64:79]
    ds_read_b128 v[236:239], v43 offset:0
    ds_read_b64_tr_b16 v[28:29], v10 offset:9216
    ds_read_b64_tr_b16 v[30:31], v10 offset:9984
    s_add_u32 m0, s26, 40960
    s_mov_b32 s57, 458752
    buffer_load_dwordx4 v8, s[36:39], s57 offen lds
    s_waitcnt lgkmcnt(5)
    v_mfma_f32_32x32x16_bf16 v[80:95], v[20:23], v[232:235], v[80:95]
    ds_read_b64_tr_b16 v[32:33], v11 offset:9248
    ds_read_b64_tr_b16 v[34:35], v11 offset:10016
    s_add_u32 m0, s26, 49152
    s_mov_b32 s57, 458752
    buffer_load_dwordx4 v9, s[4:7], s57 offen lds
    s_waitcnt lgkmcnt(5)
    v_mfma_f32_32x32x16_bf16 v[96:111], v[24:27], v[232:235], v[96:111]
    ds_read_b64_tr_b16 v[36:37], v12 offset:9280
    ds_read_b64_tr_b16 v[38:39], v12 offset:10048
    s_waitcnt lgkmcnt(4)
    v_mfma_f32_32x32x16_bf16 v[64:79], v[28:31], v[236:239], v[64:79]
    ds_read_b128 v[240:243], v40 offset:40960
    ds_read_b64_tr_b16 v[16:17], v10 offset:40960
    ds_read_b64_tr_b16 v[18:19], v10 offset:41728
    s_add_u32 m0, s26, 57344
    s_mov_b32 s57, 688128
    buffer_load_dwordx4 v8, s[36:39], s57 offen lds
    s_waitcnt lgkmcnt(5)
    v_mfma_f32_32x32x16_bf16 v[80:95], v[32:35], v[236:239], v[80:95]
    ds_read_b64_tr_b16 v[20:21], v11 offset:40992
    ds_read_b64_tr_b16 v[22:23], v11 offset:41760
    s_add_u32 m0, s26, 65536
    s_mov_b32 s57, 688128
    buffer_load_dwordx4 v9, s[4:7], s57 offen lds
    s_waitcnt lgkmcnt(5)
    v_mfma_f32_32x32x16_bf16 v[96:111], v[36:39], v[236:239], v[96:111]
    ds_read_b64_tr_b16 v[24:25], v12 offset:41024
    ds_read_b64_tr_b16 v[26:27], v12 offset:41792
    s_waitcnt lgkmcnt(4)
    v_mfma_f32_32x32x16_bf16 v[64:79], v[16:19], v[240:243], v[64:79]
    ds_read_b128 v[244:247], v41 offset:40960
    ds_read_b64_tr_b16 v[28:29], v10 offset:44032
    ds_read_b64_tr_b16 v[30:31], v10 offset:44800
    s_waitcnt lgkmcnt(5)
    v_mfma_f32_32x32x16_bf16 v[80:95], v[20:23], v[240:243], v[80:95]
    ds_read_b64_tr_b16 v[32:33], v11 offset:44064
    ds_read_b64_tr_b16 v[34:35], v11 offset:44832
    s_waitcnt lgkmcnt(5)
    v_mfma_f32_32x32x16_bf16 v[96:111], v[24:27], v[240:243], v[96:111]
    ds_read_b64_tr_b16 v[36:37], v12 offset:44096
    ds_read_b64_tr_b16 v[38:39], v12 offset:44864
    s_waitcnt lgkmcnt(4)
    v_mfma_f32_32x32x16_bf16 v[64:79], v[28:31], v[244:247], v[64:79]
    ds_read_b128 v[248:251], v42 offset:40960
    ds_read_b64_tr_b16 v[16:17], v10 offset:47104
    ds_read_b64_tr_b16 v[18:19], v10 offset:47872
    s_waitcnt lgkmcnt(5)
    v_mfma_f32_32x32x16_bf16 v[80:95], v[32:35], v[244:247], v[80:95]
    ds_read_b64_tr_b16 v[20:21], v11 offset:47136
    ds_read_b64_tr_b16 v[22:23], v11 offset:47904
    s_waitcnt lgkmcnt(5)
    v_mfma_f32_32x32x16_bf16 v[96:111], v[36:39], v[244:247], v[96:111]
    ds_read_b64_tr_b16 v[24:25], v12 offset:47168
    ds_read_b64_tr_b16 v[26:27], v12 offset:47936
    s_waitcnt vmcnt(6)
    s_barrier
    s_waitcnt lgkmcnt(4)
    v_mfma_f32_32x32x16_bf16 v[64:79], v[16:19], v[248:251], v[64:79]
    ds_read_b128 v[252:255], v43 offset:40960
    ds_read_b64_tr_b16 v[28:29], v10 offset:50176
    ds_read_b64_tr_b16 v[30:31], v10 offset:50944
    s_add_u32 m0, s26, 98304
    s_mov_b32 s57, 917504
    buffer_load_dwordx4 v8, s[36:39], s57 offen lds
    s_waitcnt lgkmcnt(5)
    v_mfma_f32_32x32x16_bf16 v[80:95], v[20:23], v[248:251], v[80:95]
    ds_read_b64_tr_b16 v[32:33], v11 offset:50208
    ds_read_b64_tr_b16 v[34:35], v11 offset:50976
    s_add_u32 m0, s26, 106496
    s_mov_b32 s57, 917504
    buffer_load_dwordx4 v9, s[4:7], s57 offen lds
    s_waitcnt lgkmcnt(5)
    v_mfma_f32_32x32x16_bf16 v[96:111], v[24:27], v[248:251], v[96:111]
    ds_read_b64_tr_b16 v[36:37], v12 offset:50240
    ds_read_b64_tr_b16 v[38:39], v12 offset:51008
    s_waitcnt lgkmcnt(4)
    v_mfma_f32_32x32x16_bf16 v[64:79], v[28:31], v[252:255], v[64:79]
    ds_read_b64_tr_b16 v[16:17], v14 offset:0
    ds_read_b64_tr_b16 v[18:19], v14 offset:512
    s_add_u32 m0, s26, 81920
    s_mov_b32 s57, 1146880
    buffer_load_dwordx4 v8, s[36:39], s57 offen lds
    s_waitcnt lgkmcnt(4)
    v_mfma_f32_32x32x16_bf16 v[80:95], v[32:35], v[252:255], v[80:95]
    ds_read_b64_tr_b16 v[20:21], v15 offset:0
    ds_read_b64_tr_b16 v[22:23], v15 offset:512
    s_add_u32 m0, s26, 90112
    s_mov_b32 s57, 1146880
    buffer_load_dwordx4 v9, s[4:7], s57 offen lds
    s_waitcnt lgkmcnt(4)
    v_mfma_f32_32x32x16_bf16 v[96:111], v[36:39], v[252:255], v[96:111]
    s_lshl_b32 s56, s67, 3
    s_add_u32 s56, s56, s50
    s_lshl_b32 s57, s56, 3
    s_set_gpr_idx_on s57, 0x1
    v_mov_b32 v120, v128
    v_mov_b32 v121, v129
    v_mov_b32 v122, v130
    v_mov_b32 v123, v131
    v_mov_b32 v124, v132
    v_mov_b32 v125, v133
    v_mov_b32 v126, v134
    v_mov_b32 v127, v135
    s_set_gpr_idx_off
    v_mfma_f32_32x32x16_bf16 v[48:63], v[112:115], v[120:123], 0
    v_mfma_f32_32x32x16_bf16 v[48:63], v[116:119], v[124:127], v[48:63]
    s_lshl_b32 s57, s56, 13
    s_add_u32 s57, s57, 0x10000
    s_lshl_b32 s58, s53, 7
    s_add_u32 s19, s57, s58
    s_cmp_eq_u32 s52, 0
    s_cselect_b32 s57, 32, 0
    v_lshlrev_b32 v43, 2, v2
    v_mov_b32 v42, 0x7fff0000
    v_cmp_gt_u32 vcc, s57, v2
    s_nop 1
    v_cndmask_b32 v43, v42, v43, vcc
    s_mul_i32 s56, s52, 3
    s_add_u32 s56, s56, s68
    s_mul_i32 s57, s53, 112
    s_add_u32 s22, s56, s57
    s_lshl_b32 s22, s22, 10
    v_max_f32 v64, 0, v64
    v_max_f32 v65, 0, v65
    v_max_f32 v66, 0, v66
    v_max_f32 v67, 0, v67
    v_max_f32 v68, 0, v68
    v_max_f32 v69, 0, v69
    v_max_f32 v70, 0, v70
    v_max_f32 v71, 0, v71
    v_mul_f32 v64, v64, v72
    v_mul_f32 v65, v65, v73
    v_mul_f32 v66, v66, v74
    v_mul_f32 v67, v67, v75
    v_mul_f32 v68, v68, v76
    v_mul_f32 v69, v69, v77
    v_mul_f32 v70, v70, v78
    v_mul_f32 v71, v71, v79
    v_mov_b32 v42, v48
    v_cvt_pk_bf16_f32 v48, v64, v65
    v_cvt_pk_bf16_f32 v49, v66, v67
    v_cvt_pk_bf16_f32 v50, v68, v69
    v_cvt_pk_bf16_f32 v51, v70, v71
    v_max_f32 v80, 0, v80
    v_max_f32 v81, 0, v81
    v_max_f32 v82, 0, v82
    v_max_f32 v83, 0, v83
    v_max_f32 v84, 0, v84
    v_max_f32 v85, 0, v85
    v_max_f32 v86, 0, v86
    v_max_f32 v87, 0, v87
    v_mul_f32 v80, v80, v88
    v_mul_f32 v81, v81, v89
    v_mul_f32 v82, v82, v90
    v_mul_f32 v83, v83, v91
    v_mul_f32 v84, v84, v92
    v_mul_f32 v85, v85, v93
    v_mul_f32 v86, v86, v94
    v_mul_f32 v87, v87, v95
    v_cvt_pk_bf16_f32 v52, v80, v81
    v_cvt_pk_bf16_f32 v53, v82, v83
    v_cvt_pk_bf16_f32 v54, v84, v85
    v_cvt_pk_bf16_f32 v55, v86, v87
    v_max_f32 v96, 0, v96
    v_max_f32 v97, 0, v97
    v_max_f32 v98, 0, v98
    v_max_f32 v99, 0, v99
    v_max_f32 v100, 0, v100
    v_max_f32 v101, 0, v101
    v_max_f32 v102, 0, v102
    v_max_f32 v103, 0, v103
    v_mul_f32 v96, v96, v104
    v_mul_f32 v97, v97, v105
    v_mul_f32 v98, v98, v106
    v_mul_f32 v99, v99, v107
    v_mul_f32 v100, v100, v108
    v_mul_f32 v101, v101, v109
    v_mul_f32 v102, v102, v110
    v_mul_f32 v103, v103, v111
    v_cvt_pk_bf16_f32 v56, v96, v97
    v_cvt_pk_bf16_f32 v57, v98, v99
    v_cvt_pk_bf16_f32 v58, v100, v101
    v_cvt_pk_bf16_f32 v59, v102, v103
    s_waitcnt lgkmcnt(2)
    v_mfma_f32_32x32x16_bf16 v[64:79], v[16:19], v[128:131], 0
    ds_read_b64_tr_b16 v[28:29], v14 offset:2048
    ds_read_b64_tr_b16 v[30:31], v14 offset:2560
    s_waitcnt lgkmcnt(2)
    v_mfma_f32_32x32x16_bf16 v[80:95], v[20:23], v[128:131], 0
    ds_read_b64_tr_b16 v[32:33], v15 offset:2048
    ds_read_b64_tr_b16 v[34:35], v15 offset:2560
    s_waitcnt lgkmcnt(2)
    v_mfma_f32_32x32x16_bf16 v[64:79], v[28:31], v[132:135], v[64:79]
    ds_read_b64_tr_b16 v[16:17], v14 offset:4096
    ds_read_b64_tr_b16 v[18:19], v14 offset:4608
    s_waitcnt lgkmcnt(2)
    v_mfma_f32_32x32x16_bf16 v[80:95], v[32:35], v[132:135], v[80:95]
    ds_read_b64_tr_b16 v[20:21], v15 offset:4096
    ds_read_b64_tr_b16 v[22:23], v15 offset:4608
    s_waitcnt vmcnt(8)
    s_barrier
    buffer_load_dword v44, v47, s[40:43], 0 offen sc1
    s_waitcnt lgkmcnt(2)
    v_mfma_f32_32x32x16_bf16 v[64:79], v[16:19], v[136:139], v[64:79]
    ds_read_b64_tr_b16 v[28:29], v14 offset:6144
    ds_read_b64_tr_b16 v[30:31], v14 offset:6656
    s_waitcnt lgkmcnt(2)
    v_mfma_f32_32x32x16_bf16 v[80:95], v[20:23], v[136:139], v[80:95]
    ds_read_b64_tr_b16 v[32:33], v15 offset:6144
    ds_read_b64_tr_b16 v[34:35], v15 offset:6656
    s_waitcnt lgkmcnt(2)
    v_mfma_f32_32x32x16_bf16 v[64:79], v[28:31], v[140:143], v[64:79]
    ds_read_b64_tr_b16 v[16:17], v14 offset:16384
    ds_read_b64_tr_b16 v[18:19], v14 offset:16896
    s_waitcnt lgkmcnt(2)
    v_mfma_f32_32x32x16_bf16 v[80:95], v[32:35], v[140:143], v[80:95]
    ds_read_b64_tr_b16 v[20:21], v15 offset:16384
    ds_read_b64_tr_b16 v[22:23], v15 offset:16896
    s_waitcnt lgkmcnt(2)
    v_mfma_f32_32x32x16_bf16 v[64:79], v[16:19], v[144:147], v[64:79]
    ds_read_b64_tr_b16 v[28:29], v14 offset:18432
    ds_read_b64_tr_b16 v[30:31], v14 offset:18944
    s_add_u32 m0, s26, 131072
    s_mov_b32 s57, 1376256
    buffer_load_dwordx4 v8, s[36:39], s57 offen lds
    s_waitcnt lgkmcnt(2)
    v_mfma_f32_32x32x16_bf16 v[80:95], v[20:23], v[144:147], v[80:95]
    ds_read_b64_tr_b16 v[32:33], v15 offset:18432
    ds_read_b64_tr_b16 v[34:35], v15 offset:18944
    s_add_u32 m0, s26, 139264
    s_mov_b32 s57, 1376256
    buffer_load_dwordx4 v9, s[4:7], s57 offen lds
    s_waitcnt lgkmcnt(2)
    v_mfma_f32_32x32x16_bf16 v[64:79], v[28:31], v[148:151], v[64:79]
    ds_read_b64_tr_b16 v[16:17], v14 offset:20480
    ds_read_b64_tr_b16 v[18:19], v14 offset:20992
    s_add_u32 m0, s26, 147456
    s_mov_b32 s57, 1605632
    buffer_load_dwordx4 v8, s[36:39], s57 offen lds
    s_waitcnt lgkmcnt(2)
    v_mfma_f32_32x32x16_bf16 v[80:95], v[32:35], v[148:151], v[80:95]
    ds_read_b64_tr_b16 v[20:21], v15 offset:20480
    ds_read_b64_tr_b16 v[22:23], v15 offset:20992
    s_add_u32 m0, s26, 155648
    s_mov_b32 s57, 1605632
    buffer_load_dwordx4 v9, s[4:7], s57 offen lds
    s_waitcnt vmcnt(11)
    s_barrier
    s_waitcnt lgkmcnt(2)
    v_mfma_f32_32x32x16_bf16 v[64:79], v[16:19], v[152:155], v[64:79]
    ds_read_b64_tr_b16 v[28:29], v14 offset:22528
    ds_read_b64_tr_b16 v[30:31], v14 offset:23040
    s_waitcnt lgkmcnt(2)
    v_mfma_f32_32x32x16_bf16 v[80:95], v[20:23], v[152:155], v[80:95]
    ds_read_b64_tr_b16 v[32:33], v15 offset:22528
    ds_read_b64_tr_b16 v[34:35], v15 offset:23040
    s_waitcnt lgkmcnt(2)
    v_mfma_f32_32x32x16_bf16 v[64:79], v[28:31], v[156:159], v[64:79]
    ds_read_b64_tr_b16 v[16:17], v14 offset:40960
    ds_read_b64_tr_b16 v[18:19], v14 offset:41472
    s_waitcnt lgkmcnt(2)
    v_mfma_f32_32x32x16_bf16 v[80:95], v[32:35], v[156:159], v[80:95]
    ds_read_b64_tr_b16 v[20:21], v15 offset:40960
    ds_read_b64_tr_b16 v[22:23], v15 offset:41472
    s_waitcnt lgkmcnt(2)
    v_mfma_f32_32x32x16_bf16 v[64:79], v[16:19], v[160:163], v[64:79]
    ds_read_b64_tr_b16 v[28:29], v14 offset:43008
    ds_read_b64_tr_b16 v[30:31], v14 offset:43520
    s_waitcnt lgkmcnt(2)
    v_mfma_f32_32x32x16_bf16 v[80:95], v[20:23], v[160:163], v[80:95]
    ds_read_b64_tr_b16 v[32:33], v15 offset:43008
    ds_read_b64_tr_b16 v[34:35], v15 offset:43520
    s_waitcnt lgkmcnt(2)
    v_mfma_f32_32x32x16_bf16 v[64:79], v[28:31], v[164:167], v[64:79]
    ds_read_b64_tr_b16 v[16:17], v14 offset:45056
    ds_read_b64_tr_b16 v[18:19], v14 offset:45568
    s_waitcnt lgkmcnt(2)
    v_mfma_f32_32x32x16_bf16 v[80:95], v[32:35], v[164:167], v[80:95]
    ds_read_b64_tr_b16 v[20:21], v15 offset:45056
    ds_read_b64_tr_b16 v[22:23], v15 offset:45568
    s_waitcnt vmcnt(4)
    s_barrier
    s_cmp_eq_u32 s48, 0
    s_cbranch_scc0 L_ok11
    v_readfirstlane_b32 s56, v44
    s_nop 0
    s_cmp_ge_u32 s56, 1
    s_cbranch_scc1 L_ok11
    s_mov_b32 s66, 0
L_poll11:
    buffer_load_dword v44, v47, s[40:43], 0 offen sc1
    s_waitcnt vmcnt(0)
    v_readfirstlane_b32 s56, v44
    s_add_u32 s66, s66, 1
    s_cmp_ge_u32 s66, 0x80000
    s_cbranch_scc1 L_ok11
    s_cmp_lt_u32 s56, 1
    s_cbranch_scc1 L_poll11
L_ok11:
    s_waitcnt lgkmcnt(2)
    v_mfma_f32_32x32x16_bf16 v[64:79], v[16:19], v[168:171], v[64:79]
    ds_read_b64_tr_b16 v[28:29], v14 offset:47104
    ds_read_b64_tr_b16 v[30:31], v14 offset:47616
    s_waitcnt lgkmcnt(2)
    v_mfma_f32_32x32x16_bf16 v[80:95], v[20:23], v[168:171], v[80:95]
    ds_read_b64_tr_b16 v[32:33], v15 offset:47104
    ds_read_b64_tr_b16 v[34:35], v15 offset:47616
    s_waitcnt lgkmcnt(2)
    v_mfma_f32_32x32x16_bf16 v[64:79], v[28:31], v[172:175], v[64:79]
    ds_read_b64_tr_b16 v[16:17], v14 offset:57344
    ds_read_b64_tr_b16 v[18:19], v14 offset:57856
    s_waitcnt lgkmcnt(2)
    v_mfma_f32_32x32x16_bf16 v[80:95], v[32:35], v[172:175], v[80:95]
    ds_read_b64_tr_b16 v[20:21], v15 offset:57344
    ds_read_b64_tr_b16 v[22:23], v15 offset:57856
    s_waitcnt lgkmcnt(2)
    v_mfma_f32_32x32x16_bf16 v[64:79], v[16:19], v[176:179], v[64:79]
    ds_read_b64_tr_b16 v[28:29], v14 offset:59392
    ds_read_b64_tr_b16 v[30:31], v14 offset:59904
    s_waitcnt lgkmcnt(2)
    v_mfma_f32_32x32x16_bf16 v[80:95], v[20:23], v[176:179], v[80:95]
    ds_read_b64_tr_b16 v[32:33], v15 offset:59392
    ds_read_b64_tr_b16 v[34:35], v15 offset:59904
    buffer_store_dword v42, v43, s[32:35], s19 offen sc1
    s_waitcnt lgkmcnt(2)
    v_mfma_f32_32x32x16_bf16 v[64:79], v[28:31], v[180:183], v[64:79]
    ds_read_b64_tr_b16 v[16:17], v14 offset:61440
    ds_read_b64_tr_b16 v[18:19], v14 offset:61952
    s_waitcnt lgkmcnt(2)
    v_mfma_f32_32x32x16_bf16 v[80:95], v[32:35], v[180:183], v[80:95]
    ds_read_b64_tr_b16 v[20:21], v15 offset:61440
    ds_read_b64_tr_b16 v[22:23], v15 offset:61952
    s_barrier
    s_waitcnt lgkmcnt(2)
    v_mfma_f32_32x32x16_bf16 v[64:79], v[16:19], v[184:187], v[64:79]
    ds_read_b64_tr_b16 v[28:29], v14 offset:63488
    ds_read_b64_tr_b16 v[30:31], v14 offset:64000
    s_waitcnt lgkmcnt(2)
    v_mfma_f32_32x32x16_bf16 v[80:95], v[20:23], v[184:187], v[80:95]
    ds_read_b64_tr_b16 v[32:33], v15 offset:63488
    ds_read_b64_tr_b16 v[34:35], v15 offset:64000
    s_waitcnt lgkmcnt(2)
    v_mfma_f32_32x32x16_bf16 v[64:79], v[28:31], v[188:191], v[64:79]
    v_add_u32 v14, 0x14000, v14
    v_add_u32 v15, 0x14000, v15
    ds_read_b64_tr_b16 v[16:17], v14 offset:16384
    ds_read_b64_tr_b16 v[18:19], v14 offset:16896
    s_waitcnt lgkmcnt(2)
    v_mfma_f32_32x32x16_bf16 v[80:95], v[32:35], v[188:191], v[80:95]
    ds_read_b64_tr_b16 v[20:21], v15 offset:16384
    ds_read_b64_tr_b16 v[22:23], v15 offset:16896
    s_waitcnt lgkmcnt(2)
    v_mfma_f32_32x32x16_bf16 v[64:79], v[16:19], v[192:195], v[64:79]
    ds_read_b64_tr_b16 v[28:29], v14 offset:18432
    ds_read_b64_tr_b16 v[30:31], v14 offset:18944
    s_waitcnt lgkmcnt(2)
    v_mfma_f32_32x32x16_bf16 v[80:95], v[20:23], v[192:195], v[80:95]
    ds_read_b64_tr_b16 v[32:33], v15 offset:18432
    ds_read_b64_tr_b16 v[34:35], v15 offset:18944
    s_waitcnt lgkmcnt(2)
    v_mfma_f32_32x32x16_bf16 v[64:79], v[28:31], v[196:199], v[64:79]
    ds_read_b64_tr_b16 v[16:17], v14 offset:20480
    ds_read_b64_tr_b16 v[18:19], v14 offset:20992
    s_waitcnt lgkmcnt(2)
    v_mfma_f32_32x32x16_bf16 v[80:95], v[32:35], v[196:199], v[80:95]
    ds_read_b64_tr_b16 v[20:21], v15 offset:20480
    ds_read_b64_tr_b16 v[22:23], v15 offset:20992
    s_barrier
    s_waitcnt lgkmcnt(2)
    v_mfma_f32_32x32x16_bf16 v[64:79], v[16:19], v[200:203], v[64:79]
    ds_read_b64_tr_b16 v[28:29], v14 offset:22528
    ds_read_b64_tr_b16 v[30:31], v14 offset:23040
    s_waitcnt lgkmcnt(2)
    v_mfma_f32_32x32x16_bf16 v[80:95], v[20:23], v[200:203], v[80:95]
    ds_read_b64_tr_b16 v[32:33], v15 offset:22528
    ds_read_b64_tr_b16 v[34:35], v15 offset:23040
    s_waitcnt lgkmcnt(2)
    v_mfma_f32_32x32x16_bf16 v[64:79], v[28:31], v[204:207], v[64:79]
    ds_read_b64_tr_b16 v[16:17], v14 offset:0
    ds_read_b64_tr_b16 v[18:19], v14 offset:512
    s_waitcnt lgkmcnt(2)
    v_mfma_f32_32x32x16_bf16 v[80:95], v[32:35], v[204:207], v[80:95]
    ds_read_b64_tr_b16 v[20:21], v15 offset:0
    ds_read_b64_tr_b16 v[22:23], v15 offset:512
    s_waitcnt lgkmcnt(2)
    v_mfma_f32_32x32x16_bf16 v[64:79], v[16:19], v[208:211], v[64:79]
    ds_read_b64_tr_b16 v[28:29], v14 offset:2048
    ds_read_b64_tr_b16 v[30:31], v14 offset:2560
    s_waitcnt lgkmcnt(2)
    v_mfma_f32_32x32x16_bf16 v[80:95], v[20:23], v[208:211], v[80:95]
    ds_read_b64_tr_b16 v[32:33], v15 offset:2048
    ds_read_b64_tr_b16 v[34:35], v15 offset:2560
    s_waitcnt lgkmcnt(2)
    v_mfma_f32_32x32x16_bf16 v[64:79], v[28:31], v[212:215], v[64:79]
    ds_read_b64_tr_b16 v[16:17], v14 offset:4096
    ds_read_b64_tr_b16 v[18:19], v14 offset:4608
    s_waitcnt lgkmcnt(2)
    v_mfma_f32_32x32x16_bf16 v[80:95], v[32:35], v[212:215], v[80:95]
    ds_read_b64_tr_b16 v[20:21], v15 offset:4096
    ds_read_b64_tr_b16 v[22:23], v15 offset:4608
    s_waitcnt vmcnt(3)
    s_barrier
    s_lshr_b32 s56, s63, 2
    s_lshl_b32 s56, s56, 8
    v_mov_b32 v45, s56
    buffer_load_dword v44, v45, s[32:35], 0 offen sc1
    v_lshlrev_b32 v3, 4, v2
    s_lshl_b32 s26, s48, 11
    s_lshl_b32 s101, s63, 16
    s_add_u32 s101, s101, s26
    s_waitcnt lgkmcnt(2)
    v_mfma_f32_32x32x16_bf16 v[64:79], v[16:19], v[216:219], v[64:79]
    ds_read_b64_tr_b16 v[28:29], v14 offset:6144
    ds_read_b64_tr_b16 v[30:31], v14 offset:6656
    s_waitcnt lgkmcnt(2)
    v_mfma_f32_32x32x16_bf16 v[80:95], v[20:23], v[216:219], v[80:95]
    ds_read_b64_tr_b16 v[32:33], v15 offset:6144
    ds_read_b64_tr_b16 v[34:35], v15 offset:6656
    s_waitcnt lgkmcnt(2)
    v_mfma_f32_32x32x16_bf16 v[64:79], v[28:31], v[220:223], v[64:79]
    v_add_u32 v14, 0xc000, v14
    v_add_u32 v15, 0xc000, v15
    ds_read_b64_tr_b16 v[16:17], v14 offset:0
    ds_read_b64_tr_b16 v[18:19], v14 offset:512
    s_waitcnt lgkmcnt(2)
    v_mfma_f32_32x32x16_bf16 v[80:95], v[32:35], v[220:223], v[80:95]
    ds_read_b64_tr_b16 v[20:21], v15 offset:0
    ds_read_b64_tr_b16 v[22:23], v15 offset:512
    s_waitcnt lgkmcnt(2)
    v_mfma_f32_32x32x16_bf16 v[64:79], v[16:19], v[224:227], v[64:79]
    ds_read_b64_tr_b16 v[28:29], v14 offset:2048
    ds_read_b64_tr_b16 v[30:31], v14 offset:2560
    s_waitcnt lgkmcnt(2)
    v_mfma_f32_32x32x16_bf16 v[80:95], v[20:23], v[224:227], v[80:95]
    ds_read_b64_tr_b16 v[32:33], v15 offset:2048
    ds_read_b64_tr_b16 v[34:35], v15 offset:2560
    s_waitcnt lgkmcnt(2)
    v_mfma_f32_32x32x16_bf16 v[64:79], v[28:31], v[228:231], v[64:79]
    ds_read_b64_tr_b16 v[16:17], v14 offset:4096
    ds_read_b64_tr_b16 v[18:19], v14 offset:4608
    s_waitcnt lgkmcnt(2)
    v_mfma_f32_32x32x16_bf16 v[80:95], v[32:35], v[228:231], v[80:95]
    ds_read_b64_tr_b16 v[20:21], v15 offset:4096
    ds_read_b64_tr_b16 v[22:23], v15 offset:4608
    s_waitcnt vmcnt(0)
    s_cmp_eq_u32 s48, 0
    s_cbranch_scc0 L_ok12
    v_readfirstlane_b32 s56, v44
    s_nop 0
    s_cmp_ge_u32 s56, 16
    s_cbranch_scc1 L_ok12
    s_mov_b32 s66, 0
L_poll12:
    buffer_load_dword v44, v45, s[32:35], 0 offen sc1
    s_waitcnt vmcnt(0)
    v_readfirstlane_b32 s56, v44
    s_add_u32 s66, s66, 1
    s_cmp_ge_u32 s66, 0x80000
    s_cbranch_scc1 L_ok12
    s_cmp_lt_u32 s56, 16
    s_cbranch_scc1 L_poll12
L_ok12:
    s_barrier
    s_add_u32 m0, s26, 32768
    s_add_u32 s57, s101, 0x400000
    buffer_load_dwordx4 v3, s[32:35], s57 offen sc1 lds
    s_add_u32 m0, s26, 33792
    s_add_u32 s57, s101, 0x400400
    buffer_load_dwordx4 v3, s[32:35], s57 offen sc1 lds
    s_add_u32 m0, s26, 98304
    s_add_u32 s57, s101, 0x600000
    buffer_load_dwordx4 v3, s[32:35], s57 offen sc1 lds
    s_add_u32 m0, s26, 99328
    s_add_u32 s57, s101, 0x600400
    buffer_load_dwordx4 v3, s[32:35], s57 offen sc1 lds
    s_lshl_b32 s56, s64, 3
    s_add_u32 s56, s56, s48
    s_lshl_b32 s57, s63, 6
    s_add_u32 s57, s57, s56
    s_lshl_b32 s58, s57, 10
    s_add_u32 s58, s58, 0x200000
    buffer_load_dwordx4 v[4:7], v13, s[32:35], s58 offen sc1
    s_lshr_b32 s58, s63, 2
    s_lshl_b32 s58, s58, 11
    s_and_b32 s57, s63, 3
    s_lshl_b32 s57, s57, 5
    s_add_u32 s58, s58, s57
    s_add_u32 s58, s58, 0x4000
    v_lshrrev_b32 v100, 2, v2
    v_lshlrev_b32 v100, 7, v100
    v_and_b32 v103, 3, v2
    v_lshl_add_u32 v100, v103, 3, v100
    buffer_load_dword v101, v100, s[32:35], s58 offen offset:4 sc1
    s_lshr_b32 s57, s56, 2
    s_lshl_b32 s57, s57, 7
    s_and_b32 s56, s56, 3
    s_lshl_b32 s56, s56, 3
    s_add_u32 s58, s58, s57
    s_add_u32 s58, s58, s56
    v_mov_b32 v103, 0
    buffer_load_dword v102, v103, s[32:35], s58 offen sc1
    s_add_u32 m0, s26, 49152
    s_add_u32 s57, s101, 0x404000
    buffer_load_dwordx4 v3, s[32:35], s57 offen sc1 lds
    s_waitcnt lgkmcnt(2)
    v_mfma_f32_32x32x16_bf16 v[64:79], v[16:19], v[232:235], v[64:79]
    ds_read_b64_tr_b16 v[28:29], v14 offset:6144
    ds_read_b64_tr_b16 v[30:31], v14 offset:6656
    s_add_u32 m0, s26, 50176
    s_add_u32 s57, s101, 0x404400
    buffer_load_dwordx4 v3, s[32:35], s57 offen sc1 lds
    s_waitcnt lgkmcnt(2)
    v_mfma_f32_32x32x16_bf16 v[80:95], v[20:23], v[232:235], v[80:95]
    ds_read_b64_tr_b16 v[32:33], v15 offset:6144
    ds_read_b64_tr_b16 v[34:35], v15 offset:6656
    s_waitcnt lgkmcnt(2)
    v_mfma_f32_32x32x16_bf16 v[64:79], v[28:31], v[236:239], v[64:79]
    ds_read_b64_tr_b16 v[16:17], v14 offset:16384
    ds_read_b64_tr_b16 v[18:19], v14 offset:16896
    s_add_u32 m0, s26, 114688
    s_add_u32 s57, s101, 0x604000
    buffer_load_dwordx4 v3, s[32:35], s57 offen sc1 lds
    s_waitcnt lgkmcnt(2)
    v_mfma_f32_32x32x16_bf16 v[80:95], v[32:35], v[236:239], v[80:95]
    ds_read_b64_tr_b16 v[20:21], v15 offset:16384
    ds_read_b64_tr_b16 v[22:23], v15 offset:16896
    s_waitcnt lgkmcnt(2)
    v_mfma_f32_32x32x16_bf16 v[64:79], v[16:19], v[240:243], v[64:79]
    ds_read_b64_tr_b16 v[28:29], v14 offset:18432
    ds_read_b64_tr_b16 v[30:31], v14 offset:18944
    s_add_u32 m0, s26, 115712
    s_add_u32 s57, s101, 0x604400
    buffer_load_dwordx4 v3, s[32:35], s57 offen sc1 lds
    s_waitcnt lgkmcnt(2)
    v_mfma_f32_32x32x16_bf16 v[80:95], v[20:23], v[240:243], v[80:95]
    ds_read_b64_tr_b16 v[32:33], v15 offset:18432
    ds_read_b64_tr_b16 v[34:35], v15 offset:18944
    s_waitcnt lgkmcnt(2)
    v_mfma_f32_32x32x16_bf16 v[64:79], v[28:31], v[244:247], v[64:79]
    ds_read_b64_tr_b16 v[16:17], v14 offset:20480
    ds_read_b64_tr_b16 v[18:19], v14 offset:20992
    s_waitcnt lgkmcnt(2)
    v_mfma_f32_32x32x16_bf16 v[80:95], v[32:35], v[244:247], v[80:95]
    ds_read_b64_tr_b16 v[20:21], v15 offset:20480
    ds_read_b64_tr_b16 v[22:23], v15 offset:20992
    s_barrier
    s_waitcnt lgkmcnt(2)
    v_mfma_f32_32x32x16_bf16 v[64:79], v[16:19], v[248:251], v[64:79]
    ds_read_b64_tr_b16 v[28:29], v14 offset:22528
    ds_read_b64_tr_b16 v[30:31], v14 offset:23040
    s_waitcnt lgkmcnt(2)
    v_mfma_f32_32x32x16_bf16 v[80:95], v[20:23], v[248:251], v[80:95]
    ds_read_b64_tr_b16 v[32:33], v15 offset:22528
    ds_read_b64_tr_b16 v[34:35], v15 offset:23040
    s_waitcnt lgkmcnt(2)
    v_mfma_f32_32x32x16_bf16 v[64:79], v[28:31], v[252:255], v[64:79]
    s_waitcnt lgkmcnt(0)
    v_mfma_f32_32x32x16_bf16 v[80:95], v[32:35], v[252:255], v[80:95]
    s_lshr_b32 s58, s27, 5
    s_lshl_b32 s56, s52, 1
    s_add_u32 s56, s56, s58
    s_mul_i32 s57, s53, 112
    s_add_u32 s68, s56, s57
    s_lshl_b32 s18, s68, 10
    s_nop 3
    v_max_f32 v64, 0, v64
    v_max_f32 v65, 0, v65
    v_max_f32 v66, 0, v66
    v_max_f32 v67, 0, v67
    v_max_f32 v68, 0, v68
    v_max_f32 v69, 0, v69
    v_max_f32 v70, 0, v70
    v_max_f32 v71, 0, v71
    v_mul_f32 v64, v64, v72
    v_mul_f32 v65, v65, v73
    v_mul_f32 v66, v66, v74
    v_mul_f32 v67, v67, v75
    v_mul_f32 v68, v68, v76
    v_mul_f32 v69, v69, v77
    v_mul_f32 v70, v70, v78
    v_mul_f32 v71, v71, v79
    v_cvt_pk_bf16_f32 v128, v64, v65
    v_cvt_pk_bf16_f32 v129, v66, v67
    v_cvt_pk_bf16_f32 v130, v68, v69
    v_cvt_pk_bf16_f32 v131, v70, v71
    v_max_f32 v80, 0, v80
    v_max_f32 v81, 0, v81
    v_max_f32 v82, 0, v82
    v_max_f32 v83, 0, v83
    v_max_f32 v84, 0, v84
    v_max_f32 v85, 0, v85
    v_max_f32 v86, 0, v86
    v_max_f32 v87, 0, v87
    v_mul_f32 v80, v80, v88
    v_mul_f32 v81, v81, v89
    v_mul_f32 v82, v82, v90
    v_mul_f32 v83, v83, v91
    v_mul_f32 v84, v84, v92
    v_mul_f32 v85, v85, v93
    v_mul_f32 v86, v86, v94
    v_mul_f32 v87, v87, v95
    v_cvt_pk_bf16_f32 v132, v80, v81
    v_cvt_pk_bf16_f32 v133, v82, v83
    v_cvt_pk_bf16_f32 v134, v84, v85
    v_cvt_pk_bf16_f32 v135, v86, v87
    v_mov_b32 v136, v48
    v_mov_b32 v137, v49
    v_mov_b32 v138, v50
    v_mov_b32 v139, v51
    v_mov_b32 v140, v52
    v_mov_b32 v141, v53
    v_mov_b32 v142, v54
    v_mov_b32 v143, v55
    v_mov_b32 v144, v56
    v_mov_b32 v145, v57
    v_mov_b32 v146, v58
    v_mov_b32 v147, v59
L_p1_join:
    v_lshlrev_b32 v3, 4, v2
    v_add_u32 v96, 32768, v3
    v_lshrrev_b32 v105, 5, v2
    v_lshlrev_b32 v105, 8, v105
    v_and_b32 v106, 15, v2
    v_lshl_add_u32 v105, v106, 4, v105
    v_add_u32 v97, 98304, v105
    v_and_b32 v106, 27, v2
    v_cmp_eq_u32 vcc, 16, v106
    v_mov_b32 v107, 0x3f803f80
    s_nop 0
    v_cndmask_b32 v107, 0, v107, vcc
    v_mov_b32 v16, v107
    v_mov_b32 v17, v107
    v_mov_b32 v18, v107
    v_mov_b32 v19, v107
    v_mov_b32 v20, v107
    v_mov_b32 v21, v107
    v_mov_b32 v22, v107
    v_mov_b32 v23, v107
    v_mov_b32 v24, v107
    v_mov_b32 v25, v107
    v_mov_b32 v26, v107
    v_mov_b32 v27, v107
    v_mov_b32 v28, v107
    v_mov_b32 v29, v107
    v_mov_b32 v30, v107
    v_mov_b32 v31, v107
    s_mov_b32 s14, 0xffff
    s_mov_b32 s15, 0xffff
    s_mov_b32 s23, s67
    s_lshl_b32 s67, s54, 2
    s_and_b32 s56, s55, 3
    s_add_u32 s67, s67, s56
    s_lshr_b32 s68, s55, 2
    s_lshr_b32 s10, s48, 1
    s_and_b32 s11, s48, 1
    s_lshl_b32 s62, s67, 1
    s_add_u32 s62, s62, s11
    s_waitcnt vmcnt(2)
    s_barrier
    ds_read_b128 v[8:11], v96
    ds_read_b128 v[12:15], v96 offset:1024
    v_max_f32_dpp v101, v101, v101 row_shr:1 row_mask:0xf bank_mask:0xf
    s_nop 1
    v_max_f32_dpp v101, v101, v101 row_shr:2 row_mask:0xf bank_mask:0xf
    s_nop 1
    v_max_f32_dpp v101, v101, v101 row_shr:4 row_mask:0xf bank_mask:0xf
    s_nop 1
    v_max_f32_dpp v101, v101, v101 row_shr:8 row_mask:0xf bank_mask:0xf
    s_nop 1
    v_max_f32_dpp v101, v101, v101 row_bcast:15 row_mask:0xa bank_mask:0xf
    s_nop 1
    v_max_f32_dpp v101, v101, v101 row_bcast:31 row_mask:0xc bank_mask:0xf
    s_nop 0
    v_readlane_b32 s56, v101, 63
    s_nop 1
    v_mul_f32 v102, s56, v102
    v_mov_b32 v103, 0x45610000
    v_cmp_le_f32 vcc, v102, v103
    s_nop 0
    s_cmp_eq_u64 vcc, exec
    s_cselect_b32 s61, 0, 1
    s_cmp_eq_u32 s61, 0
    s_cbranch_scc0 L_att_slow0
    s_waitcnt lgkmcnt(1)
    v_mfma_f32_32x32x16_bf16 v[32:47], v[8:11], v[4:7], 0
    s_setprio 3
    s_waitcnt lgkmcnt(0)
    v_mfma_f32_32x32x16_bf16 v[48:63], v[12:15], v[4:7], 0
    ds_read_b128 v[8:11], v96 offset:2048
    s_mov_b64 exec, s[14:15]
    ds_read_b128 v[16:19], v97 offset:0
    ds_read_b128 v[20:23], v97 offset:512
    s_mov_b64 exec, -1
    s_nop 3
    v_exp_f32 v32, v32
    v_exp_f32 v33, v33
    v_exp_f32 v34, v34
    v_cvt_pk_bf16_f32 v64, v32, v33
    v_exp_f32 v35, v35
    s_add_u32 s57, s18, 0xa00000
    buffer_store_dwordx4 v[128:131], v3, s[32:35], s57 offen sc1
    v_exp_f32 v36, v36
    v_cvt_pk_bf16_f32 v65, v34, v35
    v_exp_f32 v37, v37
    v_exp_f32 v38, v38
    v_cvt_pk_bf16_f32 v66, v36, v37
    v_exp_f32 v39, v39
    v_exp_f32 v40, v40
    v_cvt_pk_bf16_f32 v67, v38, v39
    v_exp_f32 v41, v41
    v_exp_f32 v42, v42
    v_cvt_pk_bf16_f32 v68, v40, v41
    v_exp_f32 v43, v43
    v_exp_f32 v44, v44
    v_cvt_pk_bf16_f32 v69, v42, v43
    v_exp_f32 v45, v45
    v_exp_f32 v46, v46
    v_exp_f32 v47, v47
    v_cvt_pk_bf16_f32 v70, v44, v45
    v_cvt_pk_bf16_f32 v71, v46, v47
    s_waitcnt lgkmcnt(0)
    v_mfma_f32_32x32x16_bf16 v[32:47], v[8:11], v[4:7], 0
    ds_read_b128 v[12:15], v96 offset:3072
    s_mov_b64 exec, s[14:15]
    ds_read_b128 v[24:27], v97 offset:1024
    ds_read_b128 v[28:31], v97 offset:1536
    s_mov_b64 exec, -1
    v_exp_f32 v48, v48
    v_exp_f32 v49, v49
    v_exp_f32 v50, v50
    v_cvt_pk_bf16_f32 v72, v48, v49
    v_exp_f32 v51, v51
    v_mfma_f32_32x32x16_bf16 v[80:95], v[16:19], v[64:67], 0
    s_add_u32 s57, s18, 0xa00400
    buffer_store_dwordx4 v[132:135], v3, s[32:35], s57 offen sc1
    v_exp_f32 v52, v52
    v_cvt_pk_bf16_f32 v73, v50, v51
    v_exp_f32 v53, v53
    v_exp_f32 v54, v54
    v_cvt_pk_bf16_f32 v74, v52, v53
    v_exp_f32 v55, v55
    v_exp_f32 v56, v56
    v_cvt_pk_bf16_f32 v75, v54, v55
    v_exp_f32 v57, v57
    v_mfma_f32_32x32x16_bf16 v[80:95], v[20:23], v[68:71], v[80:95]
    v_exp_f32 v58, v58
    v_cvt_pk_bf16_f32 v76, v56, v57
    v_exp_f32 v59, v59
    v_exp_f32 v60, v60
    v_cvt_pk_bf16_f32 v77, v58, v59
    v_exp_f32 v61, v61
    v_exp_f32 v62, v62
    v_exp_f32 v63, v63
    v_cvt_pk_bf16_f32 v78, v60, v61
    v_cvt_pk_bf16_f32 v79, v62, v63
    s_waitcnt lgkmcnt(0)
    v_mfma_f32_32x32x16_bf16 v[48:63], v[12:15], v[4:7], 0
    ds_read_b128 v[8:11], v96 offset:4096
    s_mov_b64 exec, s[14:15]
    ds_read_b128 v[16:19], v97 offset:2048
    ds_read_b128 v[20:23], v97 offset:2560
    s_mov_b64 exec, -1
    v_exp_f32 v32, v32
    v_exp_f32 v33, v33
    v_exp_f32 v34, v34
    v_cvt_pk_bf16_f32 v64, v32, v33
    v_exp_f32 v35, v35
    v_mfma_f32_32x32x16_bf16 v[80:95], v[24:27], v[72:75], v[80:95]
    s_cmp_eq_u32 s23, 0
    s_cbranch_scc1 L_noh_13
    s_add_u32 s57, s22, 0xa00000
    buffer_store_dwordx4 v[136:139], v3, s[32:35], s57 offen sc1
L_noh_13:
    v_exp_f32 v36, v36
    v_cvt_pk_bf16_f32 v65, v34, v35
    v_exp_f32 v37, v37
    v_exp_f32 v38, v38
    v_cvt_pk_bf16_f32 v66, v36, v37
    v_exp_f32 v39, v39
    v_exp_f32 v40, v40
    v_cvt_pk_bf16_f32 v67, v38, v39
    v_exp_f32 v41, v41
    v_mfma_f32_32x32x16_bf16 v[80:95], v[28:31], v[76:79], v[80:95]
    v_exp_f32 v42, v42
    v_cvt_pk_bf16_f32 v68, v40, v41
    v_exp_f32 v43, v43
    v_exp_f32 v44, v44
    v_cvt_pk_bf16_f32 v69, v42, v43
    v_exp_f32 v45, v45
    v_exp_f32 v46, v46
    v_exp_f32 v47, v47
    v_cvt_pk_bf16_f32 v70, v44, v45
    v_cvt_pk_bf16_f32 v71, v46, v47
    s_waitcnt lgkmcnt(0)
    v_mfma_f32_32x32x16_bf16 v[32:47], v[8:11], v[4:7], 0
    ds_read_b128 v[12:15], v96 offset:5120
    s_mov_b64 exec, s[14:15]
    ds_read_b128 v[24:27], v97 offset:3072
    ds_read_b128 v[28:31], v97 offset:3584
    s_mov_b64 exec, -1
    v_exp_f32 v48, v48
    v_exp_f32 v49, v49
    v_exp_f32 v50, v50
    v_cvt_pk_bf16_f32 v72, v48, v49
    v_exp_f32 v51, v51
    v_mfma_f32_32x32x16_bf16 v[80:95], v[16:19], v[64:67], v[80:95]
    s_cmp_eq_u32 s23, 0
    s_cbranch_scc1 L_noh_14
    s_add_u32 s57, s22, 0xa00400
    buffer_store_dwordx4 v[140:143], v3, s[32:35], s57 offen sc1
L_noh_14:
    v_exp_f32 v52, v52
    v_cvt_pk_bf16_f32 v73, v50, v51
    v_exp_f32 v53, v53
    v_exp_f32 v54, v54
    v_cvt_pk_bf16_f32 v74, v52, v53
    v_exp_f32 v55, v55
    v_exp_f32 v56, v56
    v_cvt_pk_bf16_f32 v75, v54, v55
    v_exp_f32 v57, v57
    v_mfma_f32_32x32x16_bf16 v[80:95], v[20:23], v[68:71], v[80:95]
    v_exp_f32 v58, v58
    v_cvt_pk_bf16_f32 v76, v56, v57
    v_exp_f32 v59, v59
    v_exp_f32 v60, v60
    v_cvt_pk_bf16_f32 v77, v58, v59
    v_exp_f32 v61, v61
    v_exp_f32 v62, v62
    v_exp_f32 v63, v63
    v_cvt_pk_bf16_f32 v78, v60, v61
    v_cvt_pk_bf16_f32 v79, v62, v63
    s_setprio 2
    s_waitcnt lgkmcnt(0)
    v_mfma_f32_32x32x16_bf16 v[48:63], v[12:15], v[4:7], 0
    ds_read_b128 v[8:11], v96 offset:6144
    s_mov_b64 exec, s[14:15]
    ds_read_b128 v[16:19], v97 offset:4096
    ds_read_b128 v[20:23], v97 offset:4608
    s_mov_b64 exec, -1
    v_exp_f32 v32, v32
    v_exp_f32 v33, v33
    v_exp_f32 v34, v34
    v_cvt_pk_bf16_f32 v64, v32, v33
    v_exp_f32 v35, v35
    v_mfma_f32_32x32x16_bf16 v[80:95], v[24:27], v[72:75], v[80:95]
    s_cmp_eq_u32 s23, 0
    s_cbranch_scc1 L_noh_15
    s_add_u32 s57, s22, 0xa00800
    buffer_store_dwordx4 v[144:147], v3, s[32:35], s57 offen sc1
L_noh_15:
    v_exp_f32 v36, v36
    v_cvt_pk_bf16_f32 v65, v34, v35
    v_exp_f32 v37, v37
    v_exp_f32 v38, v38
    v_cvt_pk_bf16_f32 v66, v36, v37
    v_exp_f32 v39, v39
    v_exp_f32 v40, v40
    v_cvt_pk_bf16_f32 v67, v38, v39
    v_exp_f32 v41, v41
    v_mfma_f32_32x32x16_bf16 v[80:95], v[28:31], v[76:79], v[80:95]
    v_exp_f32 v42, v42
    v_cvt_pk_bf16_f32 v68, v40, v41
    v_exp_f32 v43, v43
    v_exp_f32 v44, v44
    v_cvt_pk_bf16_f32 v69, v42, v43
    v_exp_f32 v45, v45
    v_exp_f32 v46, v46
    v_exp_f32 v47, v47
    v_cvt_pk_bf16_f32 v70, v44, v45
    v_cvt_pk_bf16_f32 v71, v46, v47
    s_waitcnt lgkmcnt(0)
    v_mfma_f32_32x32x16_bf16 v[32:47], v[8:11], v[4:7], 0
    ds_read_b128 v[12:15], v96 offset:7168
    s_mov_b64 exec, s[14:15]
    ds_read_b128 v[24:27], v97 offset:5120
    ds_read_b128 v[28:31], v97 offset:5632
    s_mov_b64 exec, -1
    v_exp_f32 v48, v48
    v_exp_f32 v49, v49
    v_exp_f32 v50, v50
    v_cvt_pk_bf16_f32 v72, v48, v49
    v_exp_f32 v51, v51
    v_mfma_f32_32x32x16_bf16 v[80:95], v[16:19], v[64:67], v[80:95]
    s_add_u32 m0, s26, 65536
    s_add_u32 s57, s101, 0x408000
    buffer_load_dwordx4 v3, s[32:35], s57 offen sc1 lds
    v_exp_f32 v52, v52
    v_cvt_pk_bf16_f32 v73, v50, v51
    v_exp_f32 v53, v53
    v_exp_f32 v54, v54
    v_cvt_pk_bf16_f32 v74, v52, v53
    v_exp_f32 v55, v55
    v_exp_f32 v56, v56
    v_cvt_pk_bf16_f32 v75, v54, v55
    v_exp_f32 v57, v57
    v_mfma_f32_32x32x16_bf16 v[80:95], v[20:23], v[68:71], v[80:95]
    v_exp_f32 v58, v58
    v_cvt_pk_bf16_f32 v76, v56, v57
    v_exp_f32 v59, v59
    v_exp_f32 v60, v60
    v_cvt_pk_bf16_f32 v77, v58, v59
    v_exp_f32 v61, v61
    v_exp_f32 v62, v62
    v_exp_f32 v63, v63
    v_cvt_pk_bf16_f32 v78, v60, v61
    v_cvt_pk_bf16_f32 v79, v62, v63
    s_waitcnt lgkmcnt(0)
    v_mfma_f32_32x32x16_bf16 v[48:63], v[12:15], v[4:7], 0
    ds_read_b128 v[8:11], v96 offset:8192
    s_mov_b64 exec, s[14:15]
    ds_read_b128 v[16:19], v97 offset:6144
    ds_read_b128 v[20:23], v97 offset:6656
    s_mov_b64 exec, -1
    v_exp_f32 v32, v32
    v_exp_f32 v33, v33
    v_exp_f32 v34, v34
    v_cvt_pk_bf16_f32 v64, v32, v33
    v_exp_f32 v35, v35
    v_mfma_f32_32x32x16_bf16 v[80:95], v[24:27], v[72:75], v[80:95]
    s_add_u32 m0, s26, 66560
    s_add_u32 s57, s101, 0x408400
    buffer_load_dwordx4 v3, s[32:35], s57 offen sc1 lds
    v_exp_f32 v36, v36
    v_cvt_pk_bf16_f32 v65, v34, v35
    v_exp_f32 v37, v37
    v_exp_f32 v38, v38
    v_cvt_pk_bf16_f32 v66, v36, v37
    v_exp_f32 v39, v39
    v_exp_f32 v40, v40
    v_cvt_pk_bf16_f32 v67, v38, v39
    v_exp_f32 v41, v41
    v_mfma_f32_32x32x16_bf16 v[80:95], v[28:31], v[76:79], v[80:95]
    v_exp_f32 v42, v42
    v_cvt_pk_bf16_f32 v68, v40, v41
    v_exp_f32 v43, v43
    v_exp_f32 v44, v44
    v_cvt_pk_bf16_f32 v69, v42, v43
    v_exp_f32 v45, v45
    v_exp_f32 v46, v46
    v_exp_f32 v47, v47
    v_cvt_pk_bf16_f32 v70, v44, v45
    v_cvt_pk_bf16_f32 v71, v46, v47
    s_waitcnt lgkmcnt(0)
    v_mfma_f32_32x32x16_bf16 v[32:47], v[8:11], v[4:7], 0
    ds_read_b128 v[12:15], v96 offset:9216
    s_mov_b64 exec, s[14:15]
    ds_read_b128 v[24:27], v97 offset:7168
    ds_read_b128 v[28:31], v97 offset:7680
    s_mov_b64 exec, -1
    v_exp_f32 v48, v48
    v_exp_f32 v49, v49
    v_exp_f32 v50, v50
    v_cvt_pk_bf16_f32 v72, v48, v49
    v_exp_f32 v51, v51
    v_mfma_f32_32x32x16_bf16 v[80:95], v[16:19], v[64:67], v[80:95]
    s_add_u32 m0, s26, 131072
    s_add_u32 s57, s101, 0x608000
    buffer_load_dwordx4 v3, s[32:35], s57 offen sc1 lds
    v_exp_f32 v52, v52
    v_cvt_pk_bf16_f32 v73, v50, v51
    v_exp_f32 v53, v53
    v_exp_f32 v54, v54
    v_cvt_pk_bf16_f32 v74, v52, v53
    v_exp_f32 v55, v55
    v_exp_f32 v56, v56
    v_cvt_pk_bf16_f32 v75, v54, v55
    v_exp_f32 v57, v57
    v_mfma_f32_32x32x16_bf16 v[80:95], v[20:23], v[68:71], v[80:95]
    v_exp_f32 v58, v58
    v_cvt_pk_bf16_f32 v76, v56, v57
    v_exp_f32 v59, v59
    v_exp_f32 v60, v60
    v_cvt_pk_bf16_f32 v77, v58, v59
    v_exp_f32 v61, v61
    v_exp_f32 v62, v62
    v_exp_f32 v63, v63
    v_cvt_pk_bf16_f32 v78, v60, v61
    v_cvt_pk_bf16_f32 v79, v62, v63
    s_setprio 1
    s_waitcnt lgkmcnt(0)
    v_mfma_f32_32x32x16_bf16 v[48:63], v[12:15], v[4:7], 0
    ds_read_b128 v[8:11], v96 offset:10240
    s_mov_b64 exec, s[14:15]
    ds_read_b128 v[16:19], v97 offset:8192
    ds_read_b128 v[20:23], v97 offset:8704
    s_mov_b64 exec, -1
    v_exp_f32 v32, v32
    v_exp_f32 v33, v33
    v_exp_f32 v34, v34
    v_cvt_pk_bf16_f32 v64, v32, v33
    v_exp_f32 v35, v35
    v_mfma_f32_32x32x16_bf16 v[80:95], v[24:27], v[72:75], v[80:95]
    s_add_u32 m0, s26, 132096
    s_add_u32 s57, s101, 0x608400
    buffer_load_dwordx4 v3, s[32:35], s57 offen sc1 lds
    v_exp_f32 v36, v36
    v_cvt_pk_bf16_f32 v65, v34, v35
    v_exp_f32 v37, v37
    v_exp_f32 v38, v38
    v_cvt_pk_bf16_f32 v66, v36, v37
    v_exp_f32 v39, v39
    v_exp_f32 v40, v40
    v_cvt_pk_bf16_f32 v67, v38, v39
    v_exp_f32 v41, v41
    v_mfma_f32_32x32x16_bf16 v[80:95], v[28:31], v[76:79], v[80:95]
    v_exp_f32 v42, v42
    v_cvt_pk_bf16_f32 v68, v40, v41
    v_exp_f32 v43, v43
    v_exp_f32 v44, v44
    v_cvt_pk_bf16_f32 v69, v42, v43
    v_exp_f32 v45, v45
    v_exp_f32 v46, v46
    v_exp_f32 v47, v47
    v_cvt_pk_bf16_f32 v70, v44, v45
    v_cvt_pk_bf16_f32 v71, v46, v47
    s_waitcnt lgkmcnt(0)
    v_mfma_f32_32x32x16_bf16 v[32:47], v[8:11], v[4:7], 0
    ds_read_b128 v[12:15], v96 offset:11264
    s_mov_b64 exec, s[14:15]
    ds_read_b128 v[24:27], v97 offset:9216
    ds_read_b128 v[28:31], v97 offset:9728
    s_mov_b64 exec, -1
    v_exp_f32 v48, v48
    v_exp_f32 v49, v49
    v_exp_f32 v50, v50
    v_cvt_pk_bf16_f32 v72, v48, v49
    v_exp_f32 v51, v51
    v_mfma_f32_32x32x16_bf16 v[80:95], v[16:19], v[64:67], v[80:95]
    s_add_u32 m0, s26, 81920
    s_add_u32 s57, s101, 0x40c000
    buffer_load_dwordx4 v3, s[32:35], s57 offen sc1 lds
    v_exp_f32 v52, v52
    v_cvt_pk_bf16_f32 v73, v50, v51
    v_exp_f32 v53, v53
    v_exp_f32 v54, v54
    v_cvt_pk_bf16_f32 v74, v52, v53
    v_exp_f32 v55, v55
    v_exp_f32 v56, v56
    v_cvt_pk_bf16_f32 v75, v54, v55
    v_exp_f32 v57, v57
    v_mfma_f32_32x32x16_bf16 v[80:95], v[20:23], v[68:71], v[80:95]
    v_exp_f32 v58, v58
    v_cvt_pk_bf16_f32 v76, v56, v57
    v_exp_f32 v59, v59
    v_exp_f32 v60, v60
    v_cvt_pk_bf16_f32 v77, v58, v59
    v_exp_f32 v61, v61
    v_exp_f32 v62, v62
    v_exp_f32 v63, v63
    v_cvt_pk_bf16_f32 v78, v60, v61
    v_cvt_pk_bf16_f32 v79, v62, v63
    s_waitcnt lgkmcnt(0)
    v_mfma_f32_32x32x16_bf16 v[48:63], v[12:15], v[4:7], 0
    ds_read_b128 v[8:11], v96 offset:12288
    s_mov_b64 exec, s[14:15]
    ds_read_b128 v[16:19], v97 offset:10240
    ds_read_b128 v[20:23], v97 offset:10752
    s_mov_b64 exec, -1
    v_exp_f32 v32, v32
    v_exp_f32 v33, v33
    v_exp_f32 v34, v34
    v_cvt_pk_bf16_f32 v64, v32, v33
    v_exp_f32 v35, v35
    v_mfma_f32_32x32x16_bf16 v[80:95], v[24:27], v[72:75], v[80:95]
    s_add_u32 m0, s26, 82944
    s_add_u32 s57, s101, 0x40c400
    buffer_load_dwordx4 v3, s[32:35], s57 offen sc1 lds
    v_exp_f32 v36, v36
    v_cvt_pk_bf16_f32 v65, v34, v35
    v_exp_f32 v37, v37
    v_exp_f32 v38, v38
    v_cvt_pk_bf16_f32 v66, v36, v37
    v_exp_f32 v39, v39
    v_exp_f32 v40, v40
    v_cvt_pk_bf16_f32 v67, v38, v39
    v_exp_f32 v41, v41
    v_mfma_f32_32x32x16_bf16 v[80:95], v[28:31], v[76:79], v[80:95]
    v_exp_f32 v42, v42
    v_cvt_pk_bf16_f32 v68, v40, v41
    v_exp_f32 v43, v43
    v_exp_f32 v44, v44
    v_cvt_pk_bf16_f32 v69, v42, v43
    v_exp_f32 v45, v45
    v_exp_f32 v46, v46
    v_exp_f32 v47, v47
    v_cvt_pk_bf16_f32 v70, v44, v45
    v_cvt_pk_bf16_f32 v71, v46, v47
    s_waitcnt lgkmcnt(0)
    v_mfma_f32_32x32x16_bf16 v[32:47], v[8:11], v[4:7], 0
    ds_read_b128 v[12:15], v96 offset:13312
    s_mov_b64 exec, s[14:15]
    ds_read_b128 v[24:27], v97 offset:11264
    ds_read_b128 v[28:31], v97 offset:11776
    s_mov_b64 exec, -1
    v_exp_f32 v48, v48
    v_exp_f32 v49, v49
    v_exp_f32 v50, v50
    v_cvt_pk_bf16_f32 v72, v48, v49
    v_exp_f32 v51, v51
    v_mfma_f32_32x32x16_bf16 v[80:95], v[16:19], v[64:67], v[80:95]
    s_add_u32 m0, s26, 147456
    s_add_u32 s57, s101, 0x60c000
    buffer_load_dwordx4 v3, s[32:35], s57 offen sc1 lds
    v_exp_f32 v52, v52
    v_cvt_pk_bf16_f32 v73, v50, v51
    v_exp_f32 v53, v53
    v_exp_f32 v54, v54
    v_cvt_pk_bf16_f32 v74, v52, v53
    v_exp_f32 v55, v55
    v_exp_f32 v56, v56
    v_cvt_pk_bf16_f32 v75, v54, v55
    v_exp_f32 v57, v57
    v_mfma_f32_32x32x16_bf16 v[80:95], v[20:23], v[68:71], v[80:95]
    v_exp_f32 v58, v58
    v_cvt_pk_bf16_f32 v76, v56, v57
    v_exp_f32 v59, v59
    v_exp_f32 v60, v60
    v_cvt_pk_bf16_f32 v77, v58, v59
    v_exp_f32 v61, v61
    v_exp_f32 v62, v62
    v_exp_f32 v63, v63
    v_cvt_pk_bf16_f32 v78, v60, v61
    v_cvt_pk_bf16_f32 v79, v62, v63
    s_setprio 0
    s_waitcnt lgkmcnt(0)
    v_mfma_f32_32x32x16_bf16 v[48:63], v[12:15], v[4:7], 0
    ds_read_b128 v[8:11], v96 offset:14336
    s_mov_b64 exec, s[14:15]
    ds_read_b128 v[16:19], v97 offset:12288
    ds_read_b128 v[20:23], v97 offset:12800
    s_mov_b64 exec, -1
    v_exp_f32 v32, v32
    v_exp_f32 v33, v33
    v_exp_f32 v34, v34
    v_cvt_pk_bf16_f32 v64, v32, v33
    v_exp_f32 v35, v35
    v_mfma_f32_32x32x16_bf16 v[80:95], v[24:27], v[72:75], v[80:95]
    s_add_u32 m0, s26, 148480
    s_add_u32 s57, s101, 0x60c400
    buffer_load_dwordx4 v3, s[32:35], s57 offen sc1 lds
    v_exp_f32 v36, v36
    v_cvt_pk_bf16_f32 v65, v34, v35
    v_exp_f32 v37, v37
    v_exp_f32 v38, v38
    v_cvt_pk_bf16_f32 v66, v36, v37
    v_exp_f32 v39, v39
    v_exp_f32 v40, v40
    v_cvt_pk_bf16_f32 v67, v38, v39
    v_exp_f32 v41, v41
    v_mfma_f32_32x32x16_bf16 v[80:95], v[28:31], v[76:79], v[80:95]
    v_exp_f32 v42, v42
    v_cvt_pk_bf16_f32 v68, v40, v41
    v_exp_f32 v43, v43
    v_exp_f32 v44, v44
    v_cvt_pk_bf16_f32 v69, v42, v43
    v_exp_f32 v45, v45
    v_exp_f32 v46, v46
    v_exp_f32 v47, v47
    v_cvt_pk_bf16_f32 v70, v44, v45
    v_cvt_pk_bf16_f32 v71, v46, v47
    s_waitcnt lgkmcnt(0)
    v_mfma_f32_32x32x16_bf16 v[32:47], v[8:11], v[4:7], 0
    ds_read_b128 v[12:15], v96 offset:15360
    s_mov_b64 exec, s[14:15]
    ds_read_b128 v[24:27], v97 offset:13312
    ds_read_b128 v[28:31], v97 offset:13824
    s_mov_b64 exec, -1
    v_exp_f32 v48, v48
    v_exp_f32 v49, v49
    v_exp_f32 v50, v50
    v_cvt_pk_bf16_f32 v72, v48, v49
    v_exp_f32 v51, v51
    v_mfma_f32_32x32x16_bf16 v[80:95], v[16:19], v[64:67], v[80:95]
    v_exp_f32 v52, v52
    v_cvt_pk_bf16_f32 v73, v50, v51
    v_exp_f32 v53, v53
    v_exp_f32 v54, v54
    v_cvt_pk_bf16_f32 v74, v52, v53
    v_exp_f32 v55, v55
    v_exp_f32 v56, v56
    v_cvt_pk_bf16_f32 v75, v54, v55
    v_exp_f32 v57, v57
    v_mfma_f32_32x32x16_bf16 v[80:95], v[20:23], v[68:71], v[80:95]
    v_exp_f32 v58, v58
    v_cvt_pk_bf16_f32 v76, v56, v57
    v_exp_f32 v59, v59
    v_exp_f32 v60, v60
    v_cvt_pk_bf16_f32 v77, v58, v59
    v_exp_f32 v61, v61
    v_exp_f32 v62, v62
    v_exp_f32 v63, v63
    v_cvt_pk_bf16_f32 v78, v60, v61
    v_cvt_pk_bf16_f32 v79, v62, v63
    s_waitcnt lgkmcnt(0)
    v_mfma_f32_32x32x16_bf16 v[48:63], v[12:15], v[4:7], 0
    ds_read_b128 v[8:11], v96 offset:16384
    s_mov_b64 exec, s[14:15]
    ds_read_b128 v[16:19], v97 offset:14336
    ds_read_b128 v[20:23], v97 offset:14848
    s_mov_b64 exec, -1
    v_exp_f32 v32, v32
    v_exp_f32 v33, v33
    v_exp_f32 v34, v34
    v_cvt_pk_bf16_f32 v64, v32, v33
    v_exp_f32 v35, v35
    v_mfma_f32_32x32x16_bf16 v[80:95], v[24:27], v[72:75], v[80:95]
    v_exp_f32 v36, v36
    v_cvt_pk_bf16_f32 v65, v34, v35
    v_exp_f32 v37, v37
    v_exp_f32 v38, v38
    v_cvt_pk_bf16_f32 v66, v36, v37
    v_exp_f32 v39, v39
    v_exp_f32 v40, v40
    v_cvt_pk_bf16_f32 v67, v38, v39
    v_exp_f32 v41, v41
    v_mfma_f32_32x32x16_bf16 v[80:95], v[28:31], v[76:79], v[80:95]
    v_exp_f32 v42, v42
    v_cvt_pk_bf16_f32 v68, v40, v41
    v_exp_f32 v43, v43
    v_exp_f32 v44, v44
    v_cvt_pk_bf16_f32 v69, v42, v43
    v_exp_f32 v45, v45
    v_exp_f32 v46, v46
    v_exp_f32 v47, v47
    v_cvt_pk_bf16_f32 v70, v44, v45
    v_cvt_pk_bf16_f32 v71, v46, v47
    s_waitcnt lgkmcnt(0)
    v_mfma_f32_32x32x16_bf16 v[32:47], v[8:11], v[4:7], 0
    ds_read_b128 v[12:15], v96 offset:17408
    s_mov_b64 exec, s[14:15]
    ds_read_b128 v[24:27], v97 offset:15360
    ds_read_b128 v[28:31], v97 offset:15872
    s_mov_b64 exec, -1
    v_exp_f32 v48, v48
    v_exp_f32 v49, v49
    v_exp_f32 v50, v50
    v_cvt_pk_bf16_f32 v72, v48, v49
    v_exp_f32 v51, v51
    v_mfma_f32_32x32x16_bf16 v[80:95], v[16:19], v[64:67], v[80:95]
    v_exp_f32 v52, v52
    v_cvt_pk_bf16_f32 v73, v50, v51
    v_exp_f32 v53, v53
    v_exp_f32 v54, v54
    v_cvt_pk_bf16_f32 v74, v52, v53
    v_exp_f32 v55, v55
    v_exp_f32 v56, v56
    v_cvt_pk_bf16_f32 v75, v54, v55
    v_exp_f32 v57, v57
    v_mfma_f32_32x32x16_bf16 v[80:95], v[20:23], v[68:71], v[80:95]
    v_exp_f32 v58, v58
    v_cvt_pk_bf16_f32 v76, v56, v57
    v_exp_f32 v59, v59
    v_exp_f32 v60, v60
    v_cvt_pk_bf16_f32 v77, v58, v59
    v_exp_f32 v61, v61
    v_exp_f32 v62, v62
    v_exp_f32 v63, v63
    v_cvt_pk_bf16_f32 v78, v60, v61
    v_cvt_pk_bf16_f32 v79, v62, v63
    s_setprio 3
    s_waitcnt vmcnt(6)
    s_barrier
    s_add_u32 s56, s49, 16
    s_lshl_b32 s56, s56, 8
    v_mov_b32 v104, 0x7fff0000
    v_mov_b32 v105, s56
    v_cmp_eq_u32 vcc, 0, v0
    s_nop 1
    v_cndmask_b32 v104, v104, v105, vcc
    v_mov_b32 v105, 1
    buffer_atomic_add v105, v104, s[32:35], 0 offen sc1
    s_waitcnt lgkmcnt(0)
    v_mfma_f32_32x32x16_bf16 v[48:63], v[12:15], v[4:7], 0
    ds_read_b128 v[8:11], v96 offset:18432
    s_mov_b64 exec, s[14:15]
    ds_read_b128 v[16:19], v97 offset:16384
    ds_read_b128 v[20:23], v97 offset:16896
    s_mov_b64 exec, -1
    v_exp_f32 v32, v32
    v_exp_f32 v33, v33
    v_exp_f32 v34, v34
    v_cvt_pk_bf16_f32 v64, v32, v33
    v_exp_f32 v35, v35
    v_mfma_f32_32x32x16_bf16 v[80:95], v[24:27], v[72:75], v[80:95]
    v_exp_f32 v36, v36
    v_cvt_pk_bf16_f32 v65, v34, v35
    v_exp_f32 v37, v37
    v_exp_f32 v38, v38
    v_cvt_pk_bf16_f32 v66, v36, v37
    v_exp_f32 v39, v39
    v_exp_f32 v40, v40
    v_cvt_pk_bf16_f32 v67, v38, v39
    v_exp_f32 v41, v41
    v_mfma_f32_32x32x16_bf16 v[80:95], v[28:31], v[76:79], v[80:95]
    v_exp_f32 v42, v42
    v_cvt_pk_bf16_f32 v68, v40, v41
    v_exp_f32 v43, v43
    v_exp_f32 v44, v44
    v_cvt_pk_bf16_f32 v69, v42, v43
    v_exp_f32 v45, v45
    v_exp_f32 v46, v46
    v_exp_f32 v47, v47
    v_cvt_pk_bf16_f32 v70, v44, v45
    v_cvt_pk_bf16_f32 v71, v46, v47
    s_waitcnt lgkmcnt(0)
    v_mfma_f32_32x32x16_bf16 v[32:47], v[8:11], v[4:7], 0
    ds_read_b128 v[12:15], v96 offset:19456
    s_mov_b64 exec, s[14:15]
    ds_read_b128 v[24:27], v97 offset:17408
    ds_read_b128 v[28:31], v97 offset:17920
    s_mov_b64 exec, -1
    v_exp_f32 v48, v48
    v_exp_f32 v49, v49
    v_exp_f32 v50, v50
    v_cvt_pk_bf16_f32 v72, v48, v49
    v_exp_f32 v51, v51
    v_mfma_f32_32x32x16_bf16 v[80:95], v[16:19], v[64:67], v[80:95]
    v_exp_f32 v52, v52
    v_cvt_pk_bf16_f32 v73, v50, v51
    v_exp_f32 v53, v53
    v_exp_f32 v54, v54
    v_cvt_pk_bf16_f32 v74, v52, v53
    v_exp_f32 v55, v55
    v_exp_f32 v56, v56
    v_cvt_pk_bf16_f32 v75, v54, v55
    v_exp_f32 v57, v57
    v_mfma_f32_32x32x16_bf16 v[80:95], v[20:23], v[68:71], v[80:95]
    v_exp_f32 v58, v58
    v_cvt_pk_bf16_f32 v76, v56, v57
    v_exp_f32 v59, v59
    v_exp_f32 v60, v60
    v_cvt_pk_bf16_f32 v77, v58, v59
    v_exp_f32 v61, v61
    v_exp_f32 v62, v62
    v_exp_f32 v63, v63
    v_cvt_pk_bf16_f32 v78, v60, v61
    v_cvt_pk_bf16_f32 v79, v62, v63
    s_waitcnt lgkmcnt(0)
    v_mfma_f32_32x32x16_bf16 v[48:63], v[12:15], v[4:7], 0
    ds_read_b128 v[8:11], v96 offset:20480
    s_mov_b64 exec, s[14:15]
    ds_read_b128 v[16:19], v97 offset:18432
    ds_read_b128 v[20:23], v97 offset:18944
    s_mov_b64 exec, -1
    v_exp_f32 v32, v32
    v_exp_f32 v33, v33
    v_exp_f32 v34, v34
    v_cvt_pk_bf16_f32 v64, v32, v33
    v_exp_f32 v35, v35
    v_mfma_f32_32x32x16_bf16 v[80:95], v[24:27], v[72:75], v[80:95]
    s_mov_b32 s44, s16
    s_mov_b32 s45, s17
    s_mov_b32 s46, 0x1c0000
    s_mov_b32 s47, 0x20000
    s_mul_i32 s56, s55, 57344
    s_mul_i32 s57, s48, 7168
    s_add_u32 s56, s56, s57
    v_lshlrev_b32 v100, 6, v2
    buffer_load_dword v103, v100, s[44:47], s56 offen
    s_add_u32 s56, s56, 3072
    buffer_load_dword v104, v100, s[44:47], s56 offen
    s_mov_b32 s44, s8
    s_mov_b32 s45, s9
    s_mov_b32 s46, 0x80000
    s_mov_b32 s47, 0x20000
    s_lshl_b32 s56, s55, 14
    s_lshl_b32 s57, s48, 11
    s_add_u32 s56, s56, s57
    v_and_b32 v106, 31, v2
    v_lshlrev_b32 v106, 6, v106
    buffer_load_dword v105, v106, s[44:47], s56 offen
    v_exp_f32 v36, v36
    v_cvt_pk_bf16_f32 v65, v34, v35
    v_exp_f32 v37, v37
    v_exp_f32 v38, v38
    v_cvt_pk_bf16_f32 v66, v36, v37
    v_exp_f32 v39, v39
    v_exp_f32 v40, v40
    v_cvt_pk_bf16_f32 v67, v38, v39
    v_exp_f32 v41, v41
    v_mfma_f32_32x32x16_bf16 v[80:95], v[28:31], v[76:79], v[80:95]
    v_exp_f32 v42, v42
    v_cvt_pk_bf16_f32 v68, v40, v41
    v_exp_f32 v43, v43
    v_exp_f32 v44, v44
    v_cvt_pk_bf16_f32 v69, v42, v43
    v_exp_f32 v45, v45
    v_exp_f32 v46, v46
    v_exp_f32 v47, v47
    v_cvt_pk_bf16_f32 v70, v44, v45
    v_cvt_pk_bf16_f32 v71, v46, v47
    s_waitcnt lgkmcnt(0)
    v_mfma_f32_32x32x16_bf16 v[32:47], v[8:11], v[4:7], 0
    ds_read_b128 v[12:15], v96 offset:21504
    s_mov_b64 exec, s[14:15]
    ds_read_b128 v[24:27], v97 offset:19456
    ds_read_b128 v[28:31], v97 offset:19968
    s_mov_b64 exec, -1
    v_exp_f32 v48, v48
    v_exp_f32 v49, v49
    v_exp_f32 v50, v50
    v_cvt_pk_bf16_f32 v72, v48, v49
    v_exp_f32 v51, v51
    v_mfma_f32_32x32x16_bf16 v[80:95], v[16:19], v[64:67], v[80:95]
    v_exp_f32 v52, v52
    v_cvt_pk_bf16_f32 v73, v50, v51
    v_exp_f32 v53, v53
    v_exp_f32 v54, v54
    v_cvt_pk_bf16_f32 v74, v52, v53
    v_exp_f32 v55, v55
    v_exp_f32 v56, v56
    v_cvt_pk_bf16_f32 v75, v54, v55
    v_exp_f32 v57, v57
    v_mfma_f32_32x32x16_bf16 v[80:95], v[20:23], v[68:71], v[80:95]
    v_exp_f32 v58, v58
    v_cvt_pk_bf16_f32 v76, v56, v57
    v_exp_f32 v59, v59
    v_exp_f32 v60, v60
    v_cvt_pk_bf16_f32 v77, v58, v59
    v_exp_f32 v61, v61
    v_exp_f32 v62, v62
    v_exp_f32 v63, v63
    v_cvt_pk_bf16_f32 v78, v60, v61
    v_cvt_pk_bf16_f32 v79, v62, v63
    s_setprio 2
    s_waitcnt lgkmcnt(0)
    v_mfma_f32_32x32x16_bf16 v[48:63], v[12:15], v[4:7], 0
    ds_read_b128 v[8:11], v96 offset:22528
    s_mov_b64 exec, s[14:15]
    ds_read_b128 v[16:19], v97 offset:20480
    ds_read_b128 v[20:23], v97 offset:20992
    s_mov_b64 exec, -1
    v_exp_f32 v32, v32
    v_exp_f32 v33, v33
    v_exp_f32 v34, v34
    v_cvt_pk_bf16_f32 v64, v32, v33
    v_exp_f32 v35, v35
    v_mfma_f32_32x32x16_bf16 v[80:95], v[24:27], v[72:75], v[80:95]
    v_exp_f32 v36, v36
    v_cvt_pk_bf16_f32 v65, v34, v35
    v_exp_f32 v37, v37
    v_exp_f32 v38, v38
    v_cvt_pk_bf16_f32 v66, v36, v37
    v_exp_f32 v39, v39
    v_exp_f32 v40, v40
    v_cvt_pk_bf16_f32 v67, v38, v39
    v_exp_f32 v41, v41
    v_mfma_f32_32x32x16_bf16 v[80:95], v[28:31], v[76:79], v[80:95]
    v_exp_f32 v42, v42
    v_cvt_pk_bf16_f32 v68, v40, v41
    v_exp_f32 v43, v43
    v_exp_f32 v44, v44
    v_cvt_pk_bf16_f32 v69, v42, v43
    v_exp_f32 v45, v45
    v_exp_f32 v46, v46
    v_exp_f32 v47, v47
    v_cvt_pk_bf16_f32 v70, v44, v45
    v_cvt_pk_bf16_f32 v71, v46, v47
    s_waitcnt lgkmcnt(0)
    v_mfma_f32_32x32x16_bf16 v[32:47], v[8:11], v[4:7], 0
    ds_read_b128 v[12:15], v96 offset:23552
    s_mov_b64 exec, s[14:15]
    ds_read_b128 v[24:27], v97 offset:21504
    ds_read_b128 v[28:31], v97 offset:22016
    s_mov_b64 exec, -1
    v_exp_f32 v48, v48
    v_exp_f32 v49, v49
    v_exp_f32 v50, v50
    v_cvt_pk_bf16_f32 v72, v48, v49
    v_exp_f32 v51, v51
    v_mfma_f32_32x32x16_bf16 v[80:95], v[16:19], v[64:67], v[80:95]
    v_exp_f32 v52, v52
    v_cvt_pk_bf16_f32 v73, v50, v51
    v_exp_f32 v53, v53
    v_exp_f32 v54, v54
    v_cvt_pk_bf16_f32 v74, v52, v53
    v_exp_f32 v55, v55
    v_exp_f32 v56, v56
    v_cvt_pk_bf16_f32 v75, v54, v55
    v_exp_f32 v57, v57
    v_mfma_f32_32x32x16_bf16 v[80:95], v[20:23], v[68:71], v[80:95]
    v_exp_f32 v58, v58
    v_cvt_pk_bf16_f32 v76, v56, v57
    v_exp_f32 v59, v59
    v_exp_f32 v60, v60
    v_cvt_pk_bf16_f32 v77, v58, v59
    v_exp_f32 v61, v61
    v_exp_f32 v62, v62
    v_exp_f32 v63, v63
    v_cvt_pk_bf16_f32 v78, v60, v61
    v_cvt_pk_bf16_f32 v79, v62, v63
    s_waitcnt lgkmcnt(0)
    v_mfma_f32_32x32x16_bf16 v[48:63], v[12:15], v[4:7], 0
    ds_read_b128 v[8:11], v96 offset:24576
    s_mov_b64 exec, s[14:15]
    ds_read_b128 v[16:19], v97 offset:22528
    ds_read_b128 v[20:23], v97 offset:23040
    s_mov_b64 exec, -1
    v_exp_f32 v32, v32
    v_exp_f32 v33, v33
    v_exp_f32 v34, v34
    v_cvt_pk_bf16_f32 v64, v32, v33
    v_exp_f32 v35, v35
    v_mfma_f32_32x32x16_bf16 v[80:95], v[24:27], v[72:75], v[80:95]
    v_exp_f32 v36, v36
    v_cvt_pk_bf16_f32 v65, v34, v35
    v_exp_f32 v37, v37
    v_exp_f32 v38, v38
    v_cvt_pk_bf16_f32 v66, v36, v37
    v_exp_f32 v39, v39
    v_exp_f32 v40, v40
    v_cvt_pk_bf16_f32 v67, v38, v39
    v_exp_f32 v41, v41
    v_mfma_f32_32x32x16_bf16 v[80:95], v[28:31], v[76:79], v[80:95]
    v_exp_f32 v42, v42
    v_cvt_pk_bf16_f32 v68, v40, v41
    v_exp_f32 v43, v43
    v_exp_f32 v44, v44
    v_cvt_pk_bf16_f32 v69, v42, v43
    v_exp_f32 v45, v45
    v_exp_f32 v46, v46
    v_exp_f32 v47, v47
    v_cvt_pk_bf16_f32 v70, v44, v45
    v_cvt_pk_bf16_f32 v71, v46, v47
    s_waitcnt lgkmcnt(0)
    v_mfma_f32_32x32x16_bf16 v[32:47], v[8:11], v[4:7], 0
    ds_read_b128 v[12:15], v96 offset:25600
    s_mov_b64 exec, s[14:15]
    ds_read_b128 v[24:27], v97 offset:23552
    ds_read_b128 v[28:31], v97 offset:24064
    s_mov_b64 exec, -1
    v_exp_f32 v48, v48
    v_exp_f32 v49, v49
    v_exp_f32 v50, v50
    v_cvt_pk_bf16_f32 v72, v48, v49
    v_exp_f32 v51, v51
    v_mfma_f32_32x32x16_bf16 v[80:95], v[16:19], v[64:67], v[80:95]
    v_exp_f32 v52, v52
    v_cvt_pk_bf16_f32 v73, v50, v51
    v_exp_f32 v53, v53
    v_exp_f32 v54, v54
    v_cvt_pk_bf16_f32 v74, v52, v53
    v_exp_f32 v55, v55
    v_exp_f32 v56, v56
    v_cvt_pk_bf16_f32 v75, v54, v55
    v_exp_f32 v57, v57
    v_mfma_f32_32x32x16_bf16 v[80:95], v[20:23], v[68:71], v[80:95]
    v_exp_f32 v58, v58
    v_cvt_pk_bf16_f32 v76, v56, v57
    v_exp_f32 v59, v59
    v_exp_f32 v60, v60
    v_cvt_pk_bf16_f32 v77, v58, v59
    v_exp_f32 v61, v61
    v_exp_f32 v62, v62
    v_exp_f32 v63, v63
    v_cvt_pk_bf16_f32 v78, v60, v61
    v_cvt_pk_bf16_f32 v79, v62, v63
    s_setprio 1
    s_waitcnt lgkmcnt(0)
    v_mfma_f32_32x32x16_bf16 v[48:63], v[12:15], v[4:7], 0
    ds_read_b128 v[8:11], v96 offset:26624
    s_mov_b64 exec, s[14:15]
    ds_read_b128 v[16:19], v97 offset:24576
    ds_read_b128 v[20:23], v97 offset:25088
    s_mov_b64 exec, -1
    v_exp_f32 v32, v32
    v_exp_f32 v33, v33
    v_exp_f32 v34, v34
    v_cvt_pk_bf16_f32 v64, v32, v33
    v_exp_f32 v35, v35
    v_mfma_f32_32x32x16_bf16 v[80:95], v[24:27], v[72:75], v[80:95]
    v_exp_f32 v36, v36
    v_cvt_pk_bf16_f32 v65, v34, v35
    v_exp_f32 v37, v37
    v_exp_f32 v38, v38
    v_cvt_pk_bf16_f32 v66, v36, v37
    v_exp_f32 v39, v39
    v_exp_f32 v40, v40
    v_cvt_pk_bf16_f32 v67, v38, v39
    v_exp_f32 v41, v41
    v_mfma_f32_32x32x16_bf16 v[80:95], v[28:31], v[76:79], v[80:95]
    v_exp_f32 v42, v42
    v_cvt_pk_bf16_f32 v68, v40, v41
    v_exp_f32 v43, v43
    v_exp_f32 v44, v44
    v_cvt_pk_bf16_f32 v69, v42, v43
    v_exp_f32 v45, v45
    v_exp_f32 v46, v46
    v_exp_f32 v47, v47
    v_cvt_pk_bf16_f32 v70, v44, v45
    v_cvt_pk_bf16_f32 v71, v46, v47
    s_waitcnt lgkmcnt(0)
    v_mfma_f32_32x32x16_bf16 v[32:47], v[8:11], v[4:7], 0
    ds_read_b128 v[12:15], v96 offset:27648
    s_mov_b64 exec, s[14:15]
    ds_read_b128 v[24:27], v97 offset:25600
    ds_read_b128 v[28:31], v97 offset:26112
    s_mov_b64 exec, -1
    v_exp_f32 v48, v48
    v_exp_f32 v49, v49
    v_exp_f32 v50, v50
    v_cvt_pk_bf16_f32 v72, v48, v49
    v_exp_f32 v51, v51
    v_mfma_f32_32x32x16_bf16 v[80:95], v[16:19], v[64:67], v[80:95]
    v_exp_f32 v52, v52
    v_cvt_pk_bf16_f32 v73, v50, v51
    v_exp_f32 v53, v53
    v_exp_f32 v54, v54
    v_cvt_pk_bf16_f32 v74, v52, v53
    v_exp_f32 v55, v55
    v_exp_f32 v56, v56
    v_cvt_pk_bf16_f32 v75, v54, v55
    v_exp_f32 v57, v57
    v_mfma_f32_32x32x16_bf16 v[80:95], v[20:23], v[68:71], v[80:95]
    v_exp_f32 v58, v58
    v_cvt_pk_bf16_f32 v76, v56, v57
    v_exp_f32 v59, v59
    v_exp_f32 v60, v60
    v_cvt_pk_bf16_f32 v77, v58, v59
    v_exp_f32 v61, v61
    v_exp_f32 v62, v62
    v_exp_f32 v63, v63
    v_cvt_pk_bf16_f32 v78, v60, v61
    v_cvt_pk_bf16_f32 v79, v62, v63
    s_waitcnt lgkmcnt(0)
    v_mfma_f32_32x32x16_bf16 v[48:63], v[12:15], v[4:7], 0
    ds_read_b128 v[8:11], v96 offset:28672
    s_mov_b64 exec, s[14:15]
    ds_read_b128 v[16:19], v97 offset:26624
    ds_read_b128 v[20:23], v97 offset:27136
    s_mov_b64 exec, -1
    v_exp_f32 v32, v32
    v_exp_f32 v33, v33
    v_exp_f32 v34, v34
    v_cvt_pk_bf16_f32 v64, v32, v33
    v_exp_f32 v35, v35
    v_mfma_f32_32x32x16_bf16 v[80:95], v[24:27], v[72:75], v[80:95]
    v_exp_f32 v36, v36
    v_cvt_pk_bf16_f32 v65, v34, v35
    v_exp_f32 v37, v37
    v_exp_f32 v38, v38
    v_cvt_pk_bf16_f32 v66, v36, v37
    v_exp_f32 v39, v39
    v_exp_f32 v40, v40
    v_cvt_pk_bf16_f32 v67, v38, v39
    v_exp_f32 v41, v41
    v_mfma_f32_32x32x16_bf16 v[80:95], v[28:31], v[76:79], v[80:95]
    v_exp_f32 v42, v42
    v_cvt_pk_bf16_f32 v68, v40, v41
    v_exp_f32 v43, v43
    v_exp_f32 v44, v44
    v_cvt_pk_bf16_f32 v69, v42, v43
    v_exp_f32 v45, v45
    v_exp_f32 v46, v46
    v_exp_f32 v47, v47
    v_cvt_pk_bf16_f32 v70, v44, v45
    v_cvt_pk_bf16_f32 v71, v46, v47
    s_waitcnt lgkmcnt(0)
    v_mfma_f32_32x32x16_bf16 v[32:47], v[8:11], v[4:7], 0
    ds_read_b128 v[12:15], v96 offset:29696
    s_mov_b64 exec, s[14:15]
    ds_read_b128 v[24:27], v97 offset:27648
    ds_read_b128 v[28:31], v97 offset:28160
    s_mov_b64 exec, -1
    v_exp_f32 v48, v48
    v_exp_f32 v49, v49
    v_exp_f32 v50, v50
    v_cvt_pk_bf16_f32 v72, v48, v49
    v_exp_f32 v51, v51
    v_mfma_f32_32x32x16_bf16 v[80:95], v[16:19], v[64:67], v[80:95]
    v_exp_f32 v52, v52
    v_cvt_pk_bf16_f32 v73, v50, v51
    v_exp_f32 v53, v53
    v_exp_f32 v54, v54
    v_cvt_pk_bf16_f32 v74, v52, v53
    v_exp_f32 v55, v55
    v_exp_f32 v56, v56
    v_cvt_pk_bf16_f32 v75, v54, v55
    v_exp_f32 v57, v57
    v_mfma_f32_32x32x16_bf16 v[80:95], v[20:23], v[68:71], v[80:95]
    v_exp_f32 v58, v58
    v_cvt_pk_bf16_f32 v76, v56, v57
    v_exp_f32 v59, v59
    v_exp_f32 v60, v60
    v_cvt_pk_bf16_f32 v77, v58, v59
    v_exp_f32 v61, v61
    v_exp_f32 v62, v62
    v_exp_f32 v63, v63
    v_cvt_pk_bf16_f32 v78, v60, v61
    v_cvt_pk_bf16_f32 v79, v62, v63
    s_setprio 0
    s_waitcnt lgkmcnt(0)
    v_mfma_f32_32x32x16_bf16 v[48:63], v[12:15], v[4:7], 0
    ds_read_b128 v[8:11], v96 offset:30720
    s_mov_b64 exec, s[14:15]
    ds_read_b128 v[16:19], v97 offset:28672
    ds_read_b128 v[20:23], v97 offset:29184
    s_mov_b64 exec, -1
    v_exp_f32 v32, v32
    v_exp_f32 v33, v33
    v_exp_f32 v34, v34
    v_cvt_pk_bf16_f32 v64, v32, v33
    v_exp_f32 v35, v35
    v_mfma_f32_32x32x16_bf16 v[80:95], v[24:27], v[72:75], v[80:95]
    s_lshr_b32 s56, s67, 1
    s_add_u32 s56, s56, 16
    s_lshl_b32 s56, s56, 8
    v_mov_b32 v100, s56
    buffer_load_dword v101, v100, s[32:35], 0 offen sc1
    v_exp_f32 v36, v36
    v_cvt_pk_bf16_f32 v65, v34, v35
    v_exp_f32 v37, v37
    v_exp_f32 v38, v38
    v_cvt_pk_bf16_f32 v66, v36, v37
    v_exp_f32 v39, v39
    v_exp_f32 v40, v40
    v_cvt_pk_bf16_f32 v67, v38, v39
    v_exp_f32 v41, v41
    v_mfma_f32_32x32x16_bf16 v[80:95], v[28:31], v[76:79], v[80:95]
    v_exp_f32 v42, v42
    v_cvt_pk_bf16_f32 v68, v40, v41
    v_exp_f32 v43, v43
    v_exp_f32 v44, v44
    v_cvt_pk_bf16_f32 v69, v42, v43
    v_exp_f32 v45, v45
    v_exp_f32 v46, v46
    v_exp_f32 v47, v47
    v_cvt_pk_bf16_f32 v70, v44, v45
    v_cvt_pk_bf16_f32 v71, v46, v47
    s_waitcnt lgkmcnt(0)
    v_mfma_f32_32x32x16_bf16 v[32:47], v[8:11], v[4:7], 0
    ds_read_b128 v[12:15], v96 offset:31744
    s_mov_b64 exec, s[14:15]
    ds_read_b128 v[24:27], v97 offset:29696
    ds_read_b128 v[28:31], v97 offset:30208
    s_mov_b64 exec, -1
    v_exp_f32 v48, v48
    v_exp_f32 v49, v49
    v_exp_f32 v50, v50
    v_cvt_pk_bf16_f32 v72, v48, v49
    v_exp_f32 v51, v51
    v_mfma_f32_32x32x16_bf16 v[80:95], v[16:19], v[64:67], v[80:95]
    v_exp_f32 v52, v52
    v_cvt_pk_bf16_f32 v73, v50, v51
    v_exp_f32 v53, v53
    v_exp_f32 v54, v54
    v_cvt_pk_bf16_f32 v74, v52, v53
    v_exp_f32 v55, v55
    v_exp_f32 v56, v56
    v_cvt_pk_bf16_f32 v75, v54, v55
    v_exp_f32 v57, v57
    v_mfma_f32_32x32x16_bf16 v[80:95], v[20:23], v[68:71], v[80:95]
    v_exp_f32 v58, v58
    v_cvt_pk_bf16_f32 v76, v56, v57
    v_exp_f32 v59, v59
    v_exp_f32 v60, v60
    v_cvt_pk_bf16_f32 v77, v58, v59
    v_exp_f32 v61, v61
    v_exp_f32 v62, v62
    v_exp_f32 v63, v63
    v_cvt_pk_bf16_f32 v78, v60, v61
    v_cvt_pk_bf16_f32 v79, v62, v63
    s_waitcnt lgkmcnt(0)
    v_mfma_f32_32x32x16_bf16 v[48:63], v[12:15], v[4:7], 0
    ds_read_b128 v[8:11], v96 offset:32768
    s_mov_b64 exec, s[14:15]
    ds_read_b128 v[16:19], v97 offset:30720
    ds_read_b128 v[20:23], v97 offset:31232
    s_mov_b64 exec, -1
    v_exp_f32 v32, v32
    v_exp_f32 v33, v33
    v_exp_f32 v34, v34
    v_cvt_pk_bf16_f32 v64, v32, v33
    v_exp_f32 v35, v35
    v_mfma_f32_32x32x16_bf16 v[80:95], v[24:27], v[72:75], v[80:95]
    v_exp_f32 v36, v36
    v_cvt_pk_bf16_f32 v65, v34, v35
    v_exp_f32 v37, v37
    v_exp_f32 v38, v38
    v_cvt_pk_bf16_f32 v66, v36, v37
    v_exp_f32 v39, v39
    v_exp_f32 v40, v40
    v_cvt_pk_bf16_f32 v67, v38, v39
    v_exp_f32 v41, v41
    v_mfma_f32_32x32x16_bf16 v[80:95], v[28:31], v[76:79], v[80:95]
    v_exp_f32 v42, v42
    v_cvt_pk_bf16_f32 v68, v40, v41
    v_exp_f32 v43, v43
    v_exp_f32 v44, v44
    v_cvt_pk_bf16_f32 v69, v42, v43
    v_exp_f32 v45, v45
    v_exp_f32 v46, v46
    v_exp_f32 v47, v47
    v_cvt_pk_bf16_f32 v70, v44, v45
    v_cvt_pk_bf16_f32 v71, v46, v47
    s_waitcnt lgkmcnt(0)
    v_mfma_f32_32x32x16_bf16 v[32:47], v[8:11], v[4:7], 0
    ds_read_b128 v[12:15], v96 offset:33792
    s_mov_b64 exec, s[14:15]
    ds_read_b128 v[24:27], v97 offset:31744
    ds_read_b128 v[28:31], v97 offset:32256
    s_mov_b64 exec, -1
    v_exp_f32 v48, v48
    v_exp_f32 v49, v49
    v_exp_f32 v50, v50
    v_cvt_pk_bf16_f32 v72, v48, v49
    v_exp_f32 v51, v51
    v_mfma_f32_32x32x16_bf16 v[80:95], v[16:19], v[64:67], v[80:95]
    v_exp_f32 v52, v52
    v_cvt_pk_bf16_f32 v73, v50, v51
    v_exp_f32 v53, v53
    v_exp_f32 v54, v54
    v_cvt_pk_bf16_f32 v74, v52, v53
    v_exp_f32 v55, v55
    v_exp_f32 v56, v56
    v_cvt_pk_bf16_f32 v75, v54, v55
    v_exp_f32 v57, v57
    v_mfma_f32_32x32x16_bf16 v[80:95], v[20:23], v[68:71], v[80:95]
    v_exp_f32 v58, v58
    v_cvt_pk_bf16_f32 v76, v56, v57
    v_exp_f32 v59, v59
    v_exp_f32 v60, v60
    v_cvt_pk_bf16_f32 v77, v58, v59
    v_exp_f32 v61, v61
    v_exp_f32 v62, v62
    v_exp_f32 v63, v63
    v_cvt_pk_bf16_f32 v78, v60, v61
    v_cvt_pk_bf16_f32 v79, v62, v63
    s_setprio 3
    s_waitcnt vmcnt(0)
    s_cmp_eq_u32 s48, 0
    s_cbranch_scc0 L_ok16
    v_readfirstlane_b32 s56, v101
    s_nop 0
    s_cmp_ge_u32 s56, 16
    s_cbranch_scc1 L_ok16
    s_mov_b32 s66, 0
L_poll16:
    buffer_load_dword v101, v100, s[32:35], 0 offen sc1
    s_waitcnt vmcnt(0)
    v_readfirstlane_b32 s56, v101
    s_add_u32 s66, s66, 1
    s_cmp_ge_u32 s66, 0x80000
    s_cbranch_scc1 L_ok16
    s_cmp_lt_u32 s56, 16
    s_cbranch_scc1 L_poll16
L_ok16:
    s_waitcnt lgkmcnt(0)
    s_barrier
    s_mov_b32 s36, s16
    s_mov_b32 s37, s17
    s_mov_b32 s38, 0x1c0000
    s_mov_b32 s39, 0x20000
    s_mov_b32 s28, s8
    s_mov_b32 s29, s9
    s_mov_b32 s30, 0x80000
    s_mov_b32 s31, 0x20000
    v_bfe_u32 v100, v2, 4, 1
    v_lshlrev_b32 v100, 2, v100
    v_and_b32 v101, 7, v2
    v_xor_b32 v100, v100, v101
    v_lshlrev_b32 v100, 4, v100
    s_lshl_b32 s56, s68, 7
    v_add_u32 v100, s56, v100
    v_lshrrev_b32 v101, 3, v2
    s_lshl_b32 s57, s11, 5
    v_add_u32 v101, s57, v101
    s_mul_i32 s56, s10, 448
    v_add_u32 v102, s56, v101
    v_lshl_add_u32 v112, v102, 10, v100
    s_lshl_b32 s56, s10, 7
    v_add_u32 v102, s56, v101
    v_lshl_add_u32 v113, v102, 10, v100
    s_waitcnt lgkmcnt(0)
    v_mfma_f32_32x32x16_bf16 v[48:63], v[12:15], v[4:7], 0
    ds_read_b128 v[8:11], v96 offset:34816
    s_mov_b64 exec, s[14:15]
    ds_read_b128 v[16:19], v97 offset:32768
    ds_read_b128 v[20:23], v97 offset:33280
    s_mov_b64 exec, -1
    v_exp_f32 v32, v32
    v_exp_f32 v33, v33
    v_exp_f32 v34, v34
    v_cvt_pk_bf16_f32 v64, v32, v33
    v_exp_f32 v35, v35
    v_mfma_f32_32x32x16_bf16 v[80:95], v[24:27], v[72:75], v[80:95]
    s_add_u32 m0, s3, 32768
    s_mov_b32 s57, 0
    buffer_load_dwordx4 v112, s[36:39], s57 offen lds
    v_exp_f32 v36, v36
    v_cvt_pk_bf16_f32 v65, v34, v35
    v_exp_f32 v37, v37
    v_exp_f32 v38, v38
    v_cvt_pk_bf16_f32 v66, v36, v37
    v_exp_f32 v39, v39
    v_exp_f32 v40, v40
    v_cvt_pk_bf16_f32 v67, v38, v39
    v_exp_f32 v41, v41
    v_mfma_f32_32x32x16_bf16 v[80:95], v[28:31], v[76:79], v[80:95]
    s_mul_i32 s24, s62, 112
    s_mul_i32 s57, s10, 28
    s_add_u32 s24, s24, s57
    s_lshl_b32 s24, s24, 10
    s_add_u32 s24, s24, 0xa00000
    buffer_load_dwordx4 v[128:131], v3, s[32:35], s24 offen sc1
    v_exp_f32 v42, v42
    v_cvt_pk_bf16_f32 v68, v40, v41
    v_exp_f32 v43, v43
    v_exp_f32 v44, v44
    v_cvt_pk_bf16_f32 v69, v42, v43
    v_exp_f32 v45, v45
    v_exp_f32 v46, v46
    v_exp_f32 v47, v47
    v_cvt_pk_bf16_f32 v70, v44, v45
    v_cvt_pk_bf16_f32 v71, v46, v47
    s_waitcnt lgkmcnt(0)
    v_mfma_f32_32x32x16_bf16 v[32:47], v[8:11], v[4:7], 0
    ds_read_b128 v[12:15], v96 offset:35840
    s_mov_b64 exec, s[14:15]
    ds_read_b128 v[24:27], v97 offset:33792
    ds_read_b128 v[28:31], v97 offset:34304
    s_mov_b64 exec, -1
    v_exp_f32 v48, v48
    v_exp_f32 v49, v49
    v_exp_f32 v50, v50
    v_cvt_pk_bf16_f32 v72, v48, v49
    v_exp_f32 v51, v51
    v_mfma_f32_32x32x16_bf16 v[80:95], v[16:19], v[64:67], v[80:95]
    s_add_u32 m0, s3, 33792
    s_mov_b32 s57, 8192
    buffer_load_dwordx4 v112, s[36:39], s57 offen lds
    v_exp_f32 v52, v52
    v_cvt_pk_bf16_f32 v73, v50, v51
    v_exp_f32 v53, v53
    v_exp_f32 v54, v54
    v_cvt_pk_bf16_f32 v74, v52, v53
    v_exp_f32 v55, v55
    v_exp_f32 v56, v56
    v_cvt_pk_bf16_f32 v75, v54, v55
    v_exp_f32 v57, v57
    v_mfma_f32_32x32x16_bf16 v[80:95], v[20:23], v[68:71], v[80:95]
    buffer_load_dwordx4 v[132:135], v3, s[32:35], s24 offen offset:1024 sc1
    v_exp_f32 v58, v58
    v_cvt_pk_bf16_f32 v76, v56, v57
    v_exp_f32 v59, v59
    v_exp_f32 v60, v60
    v_cvt_pk_bf16_f32 v77, v58, v59
    v_exp_f32 v61, v61
    v_exp_f32 v62, v62
    v_exp_f32 v63, v63
    v_cvt_pk_bf16_f32 v78, v60, v61
    v_cvt_pk_bf16_f32 v79, v62, v63
    s_waitcnt lgkmcnt(0)
    v_mfma_f32_32x32x16_bf16 v[48:63], v[12:15], v[4:7], 0
    ds_read_b128 v[8:11], v96 offset:36864
    s_mov_b64 exec, s[14:15]
    ds_read_b128 v[16:19], v97 offset:34816
    ds_read_b128 v[20:23], v97 offset:35328
    s_mov_b64 exec, -1
    v_exp_f32 v32, v32
    v_exp_f32 v33, v33
    v_exp_f32 v34, v34
    v_cvt_pk_bf16_f32 v64, v32, v33
    v_exp_f32 v35, v35
    v_mfma_f32_32x32x16_bf16 v[80:95], v[24:27], v[72:75], v[80:95]
    s_add_u32 m0, s3, 34816
    s_mov_b32 s57, 16384
    buffer_load_dwordx4 v112, s[36:39], s57 offen lds
    v_exp_f32 v36, v36
    v_cvt_pk_bf16_f32 v65, v34, v35
    v_exp_f32 v37, v37
    v_exp_f32 v38, v38
    v_cvt_pk_bf16_f32 v66, v36, v37
    v_exp_f32 v39, v39
    v_exp_f32 v40, v40
    v_cvt_pk_bf16_f32 v67, v38, v39
    v_exp_f32 v41, v41
    v_mfma_f32_32x32x16_bf16 v[80:95], v[28:31], v[76:79], v[80:95]
    buffer_load_dwordx4 v[136:139], v3, s[32:35], s24 offen offset:2048 sc1
    v_exp_f32 v42, v42
    v_cvt_pk_bf16_f32 v68, v40, v41
    v_exp_f32 v43, v43
    v_exp_f32 v44, v44
    v_cvt_pk_bf16_f32 v69, v42, v43
    v_exp_f32 v45, v45
    v_exp_f32 v46, v46
    v_exp_f32 v47, v47
    v_cvt_pk_bf16_f32 v70, v44, v45
    v_cvt_pk_bf16_f32 v71, v46, v47
    s_waitcnt lgkmcnt(0)
    v_mfma_f32_32x32x16_bf16 v[32:47], v[8:11], v[4:7], 0
    ds_read_b128 v[12:15], v96 offset:37888
    s_mov_b64 exec, s[14:15]
    ds_read_b128 v[24:27], v97 offset:35840
    ds_read_b128 v[28:31], v97 offset:36352
    s_mov_b64 exec, -1
    v_exp_f32 v48, v48
    v_exp_f32 v49, v49
    v_exp_f32 v50, v50
    v_cvt_pk_bf16_f32 v72, v48, v49
    v_exp_f32 v51, v51
    v_mfma_f32_32x32x16_bf16 v[80:95], v[16:19], v[64:67], v[80:95]
    s_add_u32 m0, s3, 35840
    s_mov_b32 s57, 24576
    buffer_load_dwordx4 v112, s[36:39], s57 offen lds
    v_exp_f32 v52, v52
    v_cvt_pk_bf16_f32 v73, v50, v51
    v_exp_f32 v53, v53
    v_exp_f32 v54, v54
    v_cvt_pk_bf16_f32 v74, v52, v53
    v_exp_f32 v55, v55
    v_exp_f32 v56, v56
    v_cvt_pk_bf16_f32 v75, v54, v55
    v_exp_f32 v57, v57
    v_mfma_f32_32x32x16_bf16 v[80:95], v[20:23], v[68:71], v[80:95]
    buffer_load_dwordx4 v[140:143], v3, s[32:35], s24 offen offset:3072 sc1
    s_add_u32 s24, s24, 4096
    v_exp_f32 v58, v58
    v_cvt_pk_bf16_f32 v76, v56, v57
    v_exp_f32 v59, v59
    v_exp_f32 v60, v60
    v_cvt_pk_bf16_f32 v77, v58, v59
    v_exp_f32 v61, v61
    v_exp_f32 v62, v62
    v_exp_f32 v63, v63
    v_cvt_pk_bf16_f32 v78, v60, v61
    v_cvt_pk_bf16_f32 v79, v62, v63
    s_waitcnt lgkmcnt(0)
    v_mfma_f32_32x32x16_bf16 v[48:63], v[12:15], v[4:7], 0
    ds_read_b128 v[8:11], v96 offset:38912
    s_mov_b64 exec, s[14:15]
    ds_read_b128 v[16:19], v97 offset:36864
    ds_read_b128 v[20:23], v97 offset:37376
    s_mov_b64 exec, -1
    v_exp_f32 v32, v32
    v_exp_f32 v33, v33
    v_exp_f32 v34, v34
    v_cvt_pk_bf16_f32 v64, v32, v33
    v_exp_f32 v35, v35
    v_mfma_f32_32x32x16_bf16 v[80:95], v[24:27], v[72:75], v[80:95]
    s_add_u32 m0, s3, 98304
    s_mov_b32 s57, 65536
    buffer_load_dwordx4 v112, s[36:39], s57 offen lds
    v_exp_f32 v36, v36
    v_cvt_pk_bf16_f32 v65, v34, v35
    v_exp_f32 v37, v37
    v_exp_f32 v38, v38
    v_cvt_pk_bf16_f32 v66, v36, v37
    v_exp_f32 v39, v39
    v_exp_f32 v40, v40
    v_cvt_pk_bf16_f32 v67, v38, v39
    v_exp_f32 v41, v41
    v_mfma_f32_32x32x16_bf16 v[80:95], v[28:31], v[76:79], v[80:95]
    buffer_load_dwordx4 v[144:147], v3, s[32:35], s24 offen sc1
    v_exp_f32 v42, v42
    v_cvt_pk_bf16_f32 v68, v40, v41
    v_exp_f32 v43, v43
    v_exp_f32 v44, v44
    v_cvt_pk_bf16_f32 v69, v42, v43
    v_exp_f32 v45, v45
    v_exp_f32 v46, v46
    v_exp_f32 v47, v47
    v_cvt_pk_bf16_f32 v70, v44, v45
    v_cvt_pk_bf16_f32 v71, v46, v47
    s_waitcnt lgkmcnt(0)
    v_mfma_f32_32x32x16_bf16 v[32:47], v[8:11], v[4:7], 0
    ds_read_b128 v[12:15], v96 offset:39936
    s_mov_b64 exec, s[14:15]
    ds_read_b128 v[24:27], v97 offset:37888
    ds_read_b128 v[28:31], v97 offset:38400
    s_mov_b64 exec, -1
    v_exp_f32 v48, v48
    v_exp_f32 v49, v49
    v_exp_f32 v50, v50
    v_cvt_pk_bf16_f32 v72, v48, v49
    v_exp_f32 v51, v51
    v_mfma_f32_32x32x16_bf16 v[80:95], v[16:19], v[64:67], v[80:95]
    s_add_u32 m0, s3, 99328
    s_mov_b32 s57, 73728
    buffer_load_dwordx4 v112, s[36:39], s57 offen lds
    v_exp_f32 v52, v52
    v_cvt_pk_bf16_f32 v73, v50, v51
    v_exp_f32 v53, v53
    v_exp_f32 v54, v54
    v_cvt_pk_bf16_f32 v74, v52, v53
    v_exp_f32 v55, v55
    v_exp_f32 v56, v56
    v_cvt_pk_bf16_f32 v75, v54, v55
    v_exp_f32 v57, v57
    v_mfma_f32_32x32x16_bf16 v[80:95], v[20:23], v[68:71], v[80:95]
    buffer_load_dwordx4 v[148:151], v3, s[32:35], s24 offen offset:1024 sc1
    v_exp_f32 v58, v58
    v_cvt_pk_bf16_f32 v76, v56, v57
    v_exp_f32 v59, v59
    v_exp_f32 v60, v60
    v_cvt_pk_bf16_f32 v77, v58, v59
    v_exp_f32 v61, v61
    v_exp_f32 v62, v62
    v_exp_f32 v63, v63
    v_cvt_pk_bf16_f32 v78, v60, v61
    v_cvt_pk_bf16_f32 v79, v62, v63
    s_waitcnt lgkmcnt(0)
    v_mfma_f32_32x32x16_bf16 v[48:63], v[12:15], v[4:7], 0
    ds_read_b128 v[8:11], v96 offset:40960
    s_mov_b64 exec, s[14:15]
    ds_read_b128 v[16:19], v97 offset:38912
    ds_read_b128 v[20:23], v97 offset:39424
    s_mov_b64 exec, -1
    v_exp_f32 v32, v32
    v_exp_f32 v33, v33
    v_exp_f32 v34, v34
    v_cvt_pk_bf16_f32 v64, v32, v33
    v_exp_f32 v35, v35
    v_mfma_f32_32x32x16_bf16 v[80:95], v[24:27], v[72:75], v[80:95]
    s_add_u32 m0, s3, 100352
    s_mov_b32 s57, 81920
    buffer_load_dwordx4 v112, s[36:39], s57 offen lds
    v_exp_f32 v36, v36
    v_cvt_pk_bf16_f32 v65, v34, v35
    v_exp_f32 v37, v37
    v_exp_f32 v38, v38
    v_cvt_pk_bf16_f32 v66, v36, v37
    v_exp_f32 v39, v39
    v_exp_f32 v40, v40
    v_cvt_pk_bf16_f32 v67, v38, v39
    v_exp_f32 v41, v41
    v_mfma_f32_32x32x16_bf16 v[80:95], v[28:31], v[76:79], v[80:95]
    buffer_load_dwordx4 v[152:155], v3, s[32:35], s24 offen offset:2048 sc1
    v_exp_f32 v42, v42
    v_cvt_pk_bf16_f32 v68, v40, v41
    v_exp_f32 v43, v43
    v_exp_f32 v44, v44
    v_cvt_pk_bf16_f32 v69, v42, v43
    v_exp_f32 v45, v45
    v_exp_f32 v46, v46
    v_exp_f32 v47, v47
    v_cvt_pk_bf16_f32 v70, v44, v45
    v_cvt_pk_bf16_f32 v71, v46, v47
    s_waitcnt lgkmcnt(0)
    v_mfma_f32_32x32x16_bf16 v[32:47], v[8:11], v[4:7], 0
    ds_read_b128 v[12:15], v96 offset:41984
    s_mov_b64 exec, s[14:15]
    ds_read_b128 v[24:27], v97 offset:39936
    ds_read_b128 v[28:31], v97 offset:40448
    s_mov_b64 exec, -1
    v_exp_f32 v48, v48
    v_exp_f32 v49, v49
    v_exp_f32 v50, v50
    v_cvt_pk_bf16_f32 v72, v48, v49
    v_exp_f32 v51, v51
    v_mfma_f32_32x32x16_bf16 v[80:95], v[16:19], v[64:67], v[80:95]
    s_add_u32 m0, s3, 101376
    s_mov_b32 s57, 90112
    buffer_load_dwordx4 v112, s[36:39], s57 offen lds
    v_exp_f32 v52, v52
    v_cvt_pk_bf16_f32 v73, v50, v51
    v_exp_f32 v53, v53
    v_exp_f32 v54, v54
    v_cvt_pk_bf16_f32 v74, v52, v53
    v_exp_f32 v55, v55
    v_exp_f32 v56, v56
    v_cvt_pk_bf16_f32 v75, v54, v55
    v_exp_f32 v57, v57
    v_mfma_f32_32x32x16_bf16 v[80:95], v[20:23], v[68:71], v[80:95]
    buffer_load_dwordx4 v[156:159], v3, s[32:35], s24 offen offset:3072 sc1
    s_add_u32 s24, s24, 4096
    v_exp_f32 v58, v58
    v_cvt_pk_bf16_f32 v76, v56, v57
    v_exp_f32 v59, v59
    v_exp_f32 v60, v60
    v_cvt_pk_bf16_f32 v77, v58, v59
    v_exp_f32 v61, v61
    v_exp_f32 v62, v62
    v_exp_f32 v63, v63
    v_cvt_pk_bf16_f32 v78, v60, v61
    v_cvt_pk_bf16_f32 v79, v62, v63
    s_setprio 2
    s_waitcnt lgkmcnt(0)
    v_mfma_f32_32x32x16_bf16 v[48:63], v[12:15], v[4:7], 0
    ds_read_b128 v[8:11], v96 offset:43008
    s_mov_b64 exec, s[14:15]
    ds_read_b128 v[16:19], v97 offset:40960
    ds_read_b128 v[20:23], v97 offset:41472
    s_mov_b64 exec, -1
    v_exp_f32 v32, v32
    v_exp_f32 v33, v33
    v_exp_f32 v34, v34
    v_cvt_pk_bf16_f32 v64, v32, v33
    v_exp_f32 v35, v35
    v_mfma_f32_32x32x16_bf16 v[80:95], v[24:27], v[72:75], v[80:95]
    s_add_u32 m0, s3, 0
    s_mov_b32 s57, 131072
    buffer_load_dwordx4 v112, s[36:39], s57 offen lds
    v_exp_f32 v36, v36
    v_cvt_pk_bf16_f32 v65, v34, v35
    v_exp_f32 v37, v37
    v_exp_f32 v38, v38
    v_cvt_pk_bf16_f32 v66, v36, v37
    v_exp_f32 v39, v39
    v_exp_f32 v40, v40
    v_cvt_pk_bf16_f32 v67, v38, v39
    v_exp_f32 v41, v41
    v_mfma_f32_32x32x16_bf16 v[80:95], v[28:31], v[76:79], v[80:95]
    buffer_load_dwordx4 v[160:163], v3, s[32:35], s24 offen sc1
    v_exp_f32 v42, v42
    v_cvt_pk_bf16_f32 v68, v40, v41
    v_exp_f32 v43, v43
    v_exp_f32 v44, v44
    v_cvt_pk_bf16_f32 v69, v42, v43
    v_exp_f32 v45, v45
    v_exp_f32 v46, v46
    v_exp_f32 v47, v47
    v_cvt_pk_bf16_f32 v70, v44, v45
    v_cvt_pk_bf16_f32 v71, v46, v47
    s_waitcnt lgkmcnt(0)
    v_mfma_f32_32x32x16_bf16 v[32:47], v[8:11], v[4:7], 0
    ds_read_b128 v[12:15], v96 offset:44032
    s_mov_b64 exec, s[14:15]
    ds_read_b128 v[24:27], v97 offset:41984
    ds_read_b128 v[28:31], v97 offset:42496
    s_mov_b64 exec, -1
    v_exp_f32 v48, v48
    v_exp_f32 v49, v49
    v_exp_f32 v50, v50
    v_cvt_pk_bf16_f32 v72, v48, v49
    v_exp_f32 v51, v51
    v_mfma_f32_32x32x16_bf16 v[80:95], v[16:19], v[64:67], v[80:95]
    s_add_u32 m0, s3, 1024
    s_mov_b32 s57, 139264
    buffer_load_dwordx4 v112, s[36:39], s57 offen lds
    v_exp_f32 v52, v52
    v_cvt_pk_bf16_f32 v73, v50, v51
    v_exp_f32 v53, v53
    v_exp_f32 v54, v54
    v_cvt_pk_bf16_f32 v74, v52, v53
    v_exp_f32 v55, v55
    v_exp_f32 v56, v56
    v_cvt_pk_bf16_f32 v75, v54, v55
    v_exp_f32 v57, v57
    v_mfma_f32_32x32x16_bf16 v[80:95], v[20:23], v[68:71], v[80:95]
    buffer_load_dwordx4 v[164:167], v3, s[32:35], s24 offen offset:1024 sc1
    v_exp_f32 v58, v58
    v_cvt_pk_bf16_f32 v76, v56, v57
    v_exp_f32 v59, v59
    v_exp_f32 v60, v60
    v_cvt_pk_bf16_f32 v77, v58, v59
    v_exp_f32 v61, v61
    v_exp_f32 v62, v62
    v_exp_f32 v63, v63
    v_cvt_pk_bf16_f32 v78, v60, v61
    v_cvt_pk_bf16_f32 v79, v62, v63
    s_waitcnt lgkmcnt(0)
    v_mfma_f32_32x32x16_bf16 v[48:63], v[12:15], v[4:7], 0
    ds_read_b128 v[8:11], v96 offset:45056
    s_mov_b64 exec, s[14:15]
    ds_read_b128 v[16:19], v97 offset:43008
    ds_read_b128 v[20:23], v97 offset:43520
    s_mov_b64 exec, -1
    v_exp_f32 v32, v32
    v_exp_f32 v33, v33
    v_exp_f32 v34, v34
    v_cvt_pk_bf16_f32 v64, v32, v33
    v_exp_f32 v35, v35
    v_mfma_f32_32x32x16_bf16 v[80:95], v[24:27], v[72:75], v[80:95]
    s_add_u32 m0, s3, 2048
    s_mov_b32 s57, 147456
    buffer_load_dwordx4 v112, s[36:39], s57 offen lds
    v_exp_f32 v36, v36
    v_cvt_pk_bf16_f32 v65, v34, v35
    v_exp_f32 v37, v37
    v_exp_f32 v38, v38
    v_cvt_pk_bf16_f32 v66, v36, v37
    v_exp_f32 v39, v39
    v_exp_f32 v40, v40
    v_cvt_pk_bf16_f32 v67, v38, v39
    v_exp_f32 v41, v41
    v_mfma_f32_32x32x16_bf16 v[80:95], v[28:31], v[76:79], v[80:95]
    buffer_load_dwordx4 v[168:171], v3, s[32:35], s24 offen offset:2048 sc1
    v_exp_f32 v42, v42
    v_cvt_pk_bf16_f32 v68, v40, v41
    v_exp_f32 v43, v43
    v_exp_f32 v44, v44
    v_cvt_pk_bf16_f32 v69, v42, v43
    v_exp_f32 v45, v45
    v_exp_f32 v46, v46
    v_exp_f32 v47, v47
    v_cvt_pk_bf16_f32 v70, v44, v45
    v_cvt_pk_bf16_f32 v71, v46, v47
    s_waitcnt lgkmcnt(0)
    v_mfma_f32_32x32x16_bf16 v[32:47], v[8:11], v[4:7], 0
    ds_read_b128 v[12:15], v96 offset:46080
    s_mov_b64 exec, s[14:15]
    ds_read_b128 v[24:27], v97 offset:44032
    ds_read_b128 v[28:31], v97 offset:44544
    s_mov_b64 exec, -1
    v_exp_f32 v48, v48
    v_exp_f32 v49, v49
    v_exp_f32 v50, v50
    v_cvt_pk_bf16_f32 v72, v48, v49
    v_exp_f32 v51, v51
    v_mfma_f32_32x32x16_bf16 v[80:95], v[16:19], v[64:67], v[80:95]
    s_add_u32 m0, s3, 3072
    s_mov_b32 s57, 155648
    buffer_load_dwordx4 v112, s[36:39], s57 offen lds
    v_exp_f32 v52, v52
    v_cvt_pk_bf16_f32 v73, v50, v51
    v_exp_f32 v53, v53
    v_exp_f32 v54, v54
    v_cvt_pk_bf16_f32 v74, v52, v53
    v_exp_f32 v55, v55
    v_exp_f32 v56, v56
    v_cvt_pk_bf16_f32 v75, v54, v55
    v_exp_f32 v57, v57
    v_mfma_f32_32x32x16_bf16 v[80:95], v[20:23], v[68:71], v[80:95]
    buffer_load_dwordx4 v[172:175], v3, s[32:35], s24 offen offset:3072 sc1
    s_add_u32 s24, s24, 4096
    v_exp_f32 v58, v58
    v_cvt_pk_bf16_f32 v76, v56, v57
    v_exp_f32 v59, v59
    v_exp_f32 v60, v60
    v_cvt_pk_bf16_f32 v77, v58, v59
    v_exp_f32 v61, v61
    v_exp_f32 v62, v62
    v_exp_f32 v63, v63
    v_cvt_pk_bf16_f32 v78, v60, v61
    v_cvt_pk_bf16_f32 v79, v62, v63
    s_waitcnt lgkmcnt(0)
    v_mfma_f32_32x32x16_bf16 v[48:63], v[12:15], v[4:7], 0
    ds_read_b128 v[8:11], v96 offset:47104
    s_mov_b64 exec, s[14:15]
    ds_read_b128 v[16:19], v97 offset:45056
    ds_read_b128 v[20:23], v97 offset:45568
    s_mov_b64 exec, -1
    v_exp_f32 v32, v32
    v_exp_f32 v33, v33
    v_exp_f32 v34, v34
    v_cvt_pk_bf16_f32 v64, v32, v33
    v_exp_f32 v35, v35
    v_mfma_f32_32x32x16_bf16 v[80:95], v[24:27], v[72:75], v[80:95]
    buffer_load_dwordx4 v[176:179], v3, s[32:35], s24 offen sc1
    v_exp_f32 v36, v36
    v_cvt_pk_bf16_f32 v65, v34, v35
    v_exp_f32 v37, v37
    v_exp_f32 v38, v38
    v_cvt_pk_bf16_f32 v66, v36, v37
    v_exp_f32 v39, v39
    v_exp_f32 v40, v40
    v_cvt_pk_bf16_f32 v67, v38, v39
    v_exp_f32 v41, v41
    v_mfma_f32_32x32x16_bf16 v[80:95], v[28:31], v[76:79], v[80:95]
    buffer_load_dwordx4 v[180:183], v3, s[32:35], s24 offen offset:1024 sc1
    v_exp_f32 v42, v42
    v_cvt_pk_bf16_f32 v68, v40, v41
    v_exp_f32 v43, v43
    v_exp_f32 v44, v44
    v_cvt_pk_bf16_f32 v69, v42, v43
    v_exp_f32 v45, v45
    v_exp_f32 v46, v46
    v_exp_f32 v47, v47
    v_cvt_pk_bf16_f32 v70, v44, v45
    v_cvt_pk_bf16_f32 v71, v46, v47
    s_waitcnt lgkmcnt(0)
    v_mfma_f32_32x32x16_bf16 v[32:47], v[8:11], v[4:7], 0
    ds_read_b128 v[12:15], v96 offset:48128
    s_mov_b64 exec, s[14:15]
    ds_read_b128 v[24:27], v97 offset:46080
    ds_read_b128 v[28:31], v97 offset:46592
    s_mov_b64 exec, -1
    v_exp_f32 v48, v48
    v_exp_f32 v49, v49
    v_exp_f32 v50, v50
    v_cvt_pk_bf16_f32 v72, v48, v49
    v_exp_f32 v51, v51
    v_mfma_f32_32x32x16_bf16 v[80:95], v[16:19], v[64:67], v[80:95]
    buffer_load_dwordx4 v[184:187], v3, s[32:35], s24 offen offset:2048 sc1
    v_exp_f32 v52, v52
    v_cvt_pk_bf16_f32 v73, v50, v51
    v_exp_f32 v53, v53
    v_exp_f32 v54, v54
    v_cvt_pk_bf16_f32 v74, v52, v53
    v_exp_f32 v55, v55
    v_exp_f32 v56, v56
    v_cvt_pk_bf16_f32 v75, v54, v55
    v_exp_f32 v57, v57
    v_mfma_f32_32x32x16_bf16 v[80:95], v[20:23], v[68:71], v[80:95]
    buffer_load_dwordx4 v[188:191], v3, s[32:35], s24 offen offset:3072 sc1
    s_add_u32 s24, s24, 4096
    v_exp_f32 v58, v58
    v_cvt_pk_bf16_f32 v76, v56, v57
    v_exp_f32 v59, v59
    v_exp_f32 v60, v60
    v_cvt_pk_bf16_f32 v77, v58, v59
    v_exp_f32 v61, v61
    v_exp_f32 v62, v62
    v_exp_f32 v63, v63
    v_cvt_pk_bf16_f32 v78, v60, v61
    v_cvt_pk_bf16_f32 v79, v62, v63
    s_waitcnt lgkmcnt(0)
    v_mfma_f32_32x32x16_bf16 v[48:63], v[12:15], v[4:7], 0
    ds_read_b128 v[8:11], v96 offset:49152
    s_mov_b64 exec, s[14:15]
    ds_read_b128 v[16:19], v97 offset:47104
    ds_read_b128 v[20:23], v97 offset:47616
    s_mov_b64 exec, -1
    v_exp_f32 v32, v32
    v_exp_f32 v33, v33
    v_exp_f32 v34, v34
    v_cvt_pk_bf16_f32 v64, v32, v33
    v_exp_f32 v35, v35
    v_mfma_f32_32x32x16_bf16 v[80:95], v[24:27], v[72:75], v[80:95]
    buffer_load_dwordx4 v[192:195], v3, s[32:35], s24 offen sc1
    v_exp_f32 v36, v36
    v_cvt_pk_bf16_f32 v65, v34, v35
    v_exp_f32 v37, v37
    v_exp_f32 v38, v38
    v_cvt_pk_bf16_f32 v66, v36, v37
    v_exp_f32 v39, v39
    v_exp_f32 v40, v40
    v_cvt_pk_bf16_f32 v67, v38, v39
    v_exp_f32 v41, v41
    v_mfma_f32_32x32x16_bf16 v[80:95], v[28:31], v[76:79], v[80:95]
    buffer_load_dwordx4 v[196:199], v3, s[32:35], s24 offen offset:1024 sc1
    v_exp_f32 v42, v42
    v_cvt_pk_bf16_f32 v68, v40, v41
    v_exp_f32 v43, v43
    v_exp_f32 v44, v44
    v_cvt_pk_bf16_f32 v69, v42, v43
    v_exp_f32 v45, v45
    v_exp_f32 v46, v46
    v_exp_f32 v47, v47
    v_cvt_pk_bf16_f32 v70, v44, v45
    v_cvt_pk_bf16_f32 v71, v46, v47
    s_waitcnt lgkmcnt(0)
    v_mfma_f32_32x32x16_bf16 v[32:47], v[8:11], v[4:7], 0
    ds_read_b128 v[12:15], v96 offset:50176
    s_mov_b64 exec, s[14:15]
    ds_read_b128 v[24:27], v97 offset:48128
    ds_read_b128 v[28:31], v97 offset:48640
    s_mov_b64 exec, -1
    v_exp_f32 v48, v48
    v_exp_f32 v49, v49
    v_exp_f32 v50, v50
    v_cvt_pk_bf16_f32 v72, v48, v49
    v_exp_f32 v51, v51
    v_mfma_f32_32x32x16_bf16 v[80:95], v[16:19], v[64:67], v[80:95]
    buffer_load_dwordx4 v[200:203], v3, s[32:35], s24 offen offset:2048 sc1
    v_exp_f32 v52, v52
    v_cvt_pk_bf16_f32 v73, v50, v51
    v_exp_f32 v53, v53
    v_exp_f32 v54, v54
    v_cvt_pk_bf16_f32 v74, v52, v53
    v_exp_f32 v55, v55
    v_exp_f32 v56, v56
    v_cvt_pk_bf16_f32 v75, v54, v55
    v_exp_f32 v57, v57
    v_mfma_f32_32x32x16_bf16 v[80:95], v[20:23], v[68:71], v[80:95]
    buffer_load_dwordx4 v[204:207], v3, s[32:35], s24 offen offset:3072 sc1
    s_add_u32 s24, s24, 4096
    v_exp_f32 v58, v58
    v_cvt_pk_bf16_f32 v76, v56, v57
    v_exp_f32 v59, v59
    v_exp_f32 v60, v60
    v_cvt_pk_bf16_f32 v77, v58, v59
    v_exp_f32 v61, v61
    v_exp_f32 v62, v62
    v_exp_f32 v63, v63
    v_cvt_pk_bf16_f32 v78, v60, v61
    v_cvt_pk_bf16_f32 v79, v62, v63
    s_setprio 1
    s_waitcnt lgkmcnt(0)
    v_mfma_f32_32x32x16_bf16 v[48:63], v[12:15], v[4:7], 0
    ds_read_b128 v[8:11], v96 offset:51200
    s_mov_b64 exec, s[14:15]
    ds_read_b128 v[16:19], v97 offset:49152
    ds_read_b128 v[20:23], v97 offset:49664
    s_mov_b64 exec, -1
    v_exp_f32 v32, v32
    v_exp_f32 v33, v33
    v_exp_f32 v34, v34
    v_cvt_pk_bf16_f32 v64, v32, v33
    v_exp_f32 v35, v35
    v_mfma_f32_32x32x16_bf16 v[80:95], v[24:27], v[72:75], v[80:95]
    buffer_load_dwordx4 v[208:211], v3, s[32:35], s24 offen sc1
    v_exp_f32 v36, v36
    v_cvt_pk_bf16_f32 v65, v34, v35
    v_exp_f32 v37, v37
    v_exp_f32 v38, v38
    v_cvt_pk_bf16_f32 v66, v36, v37
    v_exp_f32 v39, v39
    v_exp_f32 v40, v40
    v_cvt_pk_bf16_f32 v67, v38, v39
    v_exp_f32 v41, v41
    v_mfma_f32_32x32x16_bf16 v[80:95], v[28:31], v[76:79], v[80:95]
    buffer_load_dwordx4 v[212:215], v3, s[32:35], s24 offen offset:1024 sc1
    v_exp_f32 v42, v42
    v_cvt_pk_bf16_f32 v68, v40, v41
    v_exp_f32 v43, v43
    v_exp_f32 v44, v44
    v_cvt_pk_bf16_f32 v69, v42, v43
    v_exp_f32 v45, v45
    v_exp_f32 v46, v46
    v_exp_f32 v47, v47
    v_cvt_pk_bf16_f32 v70, v44, v45
    v_cvt_pk_bf16_f32 v71, v46, v47
    s_waitcnt lgkmcnt(0)
    v_mfma_f32_32x32x16_bf16 v[32:47], v[8:11], v[4:7], 0
    ds_read_b128 v[12:15], v96 offset:52224
    s_mov_b64 exec, s[14:15]
    ds_read_b128 v[24:27], v97 offset:50176
    ds_read_b128 v[28:31], v97 offset:50688
    s_mov_b64 exec, -1
    v_exp_f32 v48, v48
    v_exp_f32 v49, v49
    v_exp_f32 v50, v50
    v_cvt_pk_bf16_f32 v72, v48, v49
    v_exp_f32 v51, v51
    v_mfma_f32_32x32x16_bf16 v[80:95], v[16:19], v[64:67], v[80:95]
    buffer_load_dwordx4 v[216:219], v3, s[32:35], s24 offen offset:2048 sc1
    v_exp_f32 v52, v52
    v_cvt_pk_bf16_f32 v73, v50, v51
    v_exp_f32 v53, v53
    v_exp_f32 v54, v54
    v_cvt_pk_bf16_f32 v74, v52, v53
    v_exp_f32 v55, v55
    v_exp_f32 v56, v56
    v_cvt_pk_bf16_f32 v75, v54, v55
    v_exp_f32 v57, v57
    v_mfma_f32_32x32x16_bf16 v[80:95], v[20:23], v[68:71], v[80:95]
    v_exp_f32 v58, v58
    v_cvt_pk_bf16_f32 v76, v56, v57
    v_exp_f32 v59, v59
    v_exp_f32 v60, v60
    v_cvt_pk_bf16_f32 v77, v58, v59
    v_exp_f32 v61, v61
    v_exp_f32 v62, v62
    v_exp_f32 v63, v63
    v_cvt_pk_bf16_f32 v78, v60, v61
    v_cvt_pk_bf16_f32 v79, v62, v63
    s_waitcnt lgkmcnt(0)
    v_mfma_f32_32x32x16_bf16 v[48:63], v[12:15], v[4:7], 0
    ds_read_b128 v[8:11], v96 offset:53248
    s_mov_b64 exec, s[14:15]
    ds_read_b128 v[16:19], v97 offset:51200
    ds_read_b128 v[20:23], v97 offset:51712
    s_mov_b64 exec, -1
    v_exp_f32 v32, v32
    v_exp_f32 v33, v33
    v_exp_f32 v34, v34
    v_cvt_pk_bf16_f32 v64, v32, v33
    v_exp_f32 v35, v35
    v_mfma_f32_32x32x16_bf16 v[80:95], v[24:27], v[72:75], v[80:95]
    buffer_load_dwordx4 v[220:223], v3, s[32:35], s24 offen offset:3072 sc1
    s_add_u32 s24, s24, 4096
    v_exp_f32 v36, v36
    v_cvt_pk_bf16_f32 v65, v34, v35
    v_exp_f32 v37, v37
    v_exp_f32 v38, v38
    v_cvt_pk_bf16_f32 v66, v36, v37
    v_exp_f32 v39, v39
    v_exp_f32 v40, v40
    v_cvt_pk_bf16_f32 v67, v38, v39
    v_exp_f32 v41, v41
    v_mfma_f32_32x32x16_bf16 v[80:95], v[28:31], v[76:79], v[80:95]
    v_exp_f32 v42, v42
    v_cvt_pk_bf16_f32 v68, v40, v41
    v_exp_f32 v43, v43
    v_exp_f32 v44, v44
    v_cvt_pk_bf16_f32 v69, v42, v43
    v_exp_f32 v45, v45
    v_exp_f32 v46, v46
    v_exp_f32 v47, v47
    v_cvt_pk_bf16_f32 v70, v44, v45
    v_cvt_pk_bf16_f32 v71, v46, v47
    s_waitcnt lgkmcnt(0)
    v_mfma_f32_32x32x16_bf16 v[32:47], v[8:11], v[4:7], 0
    ds_read_b128 v[12:15], v96 offset:54272
    s_mov_b64 exec, s[14:15]
    ds_read_b128 v[24:27], v97 offset:52224
    ds_read_b128 v[28:31], v97 offset:52736
    s_mov_b64 exec, -1
    v_exp_f32 v48, v48
    v_exp_f32 v49, v49
    v_exp_f32 v50, v50
    v_cvt_pk_bf16_f32 v72, v48, v49
    v_exp_f32 v51, v51
    v_mfma_f32_32x32x16_bf16 v[80:95], v[16:19], v[64:67], v[80:95]
    buffer_load_dwordx4 v[224:227], v3, s[32:35], s24 offen sc1
    v_exp_f32 v52, v52
    v_cvt_pk_bf16_f32 v73, v50, v51
    v_exp_f32 v53, v53
    v_exp_f32 v54, v54
    v_cvt_pk_bf16_f32 v74, v52, v53
    v_exp_f32 v55, v55
    v_exp_f32 v56, v56
    v_cvt_pk_bf16_f32 v75, v54, v55
    v_exp_f32 v57, v57
    v_mfma_f32_32x32x16_bf16 v[80:95], v[20:23], v[68:71], v[80:95]
    v_exp_f32 v58, v58
    v_cvt_pk_bf16_f32 v76, v56, v57
    v_exp_f32 v59, v59
    v_exp_f32 v60, v60
    v_cvt_pk_bf16_f32 v77, v58, v59
    v_exp_f32 v61, v61
    v_exp_f32 v62, v62
    v_exp_f32 v63, v63
    v_cvt_pk_bf16_f32 v78, v60, v61
    v_cvt_pk_bf16_f32 v79, v62, v63
    s_waitcnt lgkmcnt(0)
    v_mfma_f32_32x32x16_bf16 v[48:63], v[12:15], v[4:7], 0
    ds_read_b128 v[8:11], v96 offset:55296
    s_mov_b64 exec, s[14:15]
    ds_read_b128 v[16:19], v97 offset:53248
    ds_read_b128 v[20:23], v97 offset:53760
    s_mov_b64 exec, -1
    v_exp_f32 v32, v32
    v_exp_f32 v33, v33
    v_exp_f32 v34, v34
    v_cvt_pk_bf16_f32 v64, v32, v33
    v_exp_f32 v35, v35
    v_mfma_f32_32x32x16_bf16 v[80:95], v[24:27], v[72:75], v[80:95]
    buffer_load_dwordx4 v[228:231], v3, s[32:35], s24 offen offset:1024 sc1
    v_exp_f32 v36, v36
    v_cvt_pk_bf16_f32 v65, v34, v35
    v_exp_f32 v37, v37
    v_exp_f32 v38, v38
    v_cvt_pk_bf16_f32 v66, v36, v37
    v_exp_f32 v39, v39
    v_exp_f32 v40, v40
    v_cvt_pk_bf16_f32 v67, v38, v39
    v_exp_f32 v41, v41
    v_mfma_f32_32x32x16_bf16 v[80:95], v[28:31], v[76:79], v[80:95]
    v_exp_f32 v42, v42
    v_cvt_pk_bf16_f32 v68, v40, v41
    v_exp_f32 v43, v43
    v_exp_f32 v44, v44
    v_cvt_pk_bf16_f32 v69, v42, v43
    v_exp_f32 v45, v45
    v_exp_f32 v46, v46
    v_exp_f32 v47, v47
    v_cvt_pk_bf16_f32 v70, v44, v45
    v_cvt_pk_bf16_f32 v71, v46, v47
    s_waitcnt lgkmcnt(0)
    v_mfma_f32_32x32x16_bf16 v[32:47], v[8:11], v[4:7], 0
    ds_read_b128 v[12:15], v96 offset:56320
    s_mov_b64 exec, s[14:15]
    ds_read_b128 v[24:27], v97 offset:54272
    ds_read_b128 v[28:31], v97 offset:54784
    s_mov_b64 exec, -1
    v_exp_f32 v48, v48
    v_exp_f32 v49, v49
    v_exp_f32 v50, v50
    v_cvt_pk_bf16_f32 v72, v48, v49
    v_exp_f32 v51, v51
    v_mfma_f32_32x32x16_bf16 v[80:95], v[16:19], v[64:67], v[80:95]
    buffer_load_dwordx4 v[232:235], v3, s[32:35], s24 offen offset:2048 sc1
    v_exp_f32 v52, v52
    v_cvt_pk_bf16_f32 v73, v50, v51
    v_exp_f32 v53, v53
    v_exp_f32 v54, v54
    v_cvt_pk_bf16_f32 v74, v52, v53
    v_exp_f32 v55, v55
    v_exp_f32 v56, v56
    v_cvt_pk_bf16_f32 v75, v54, v55
    v_exp_f32 v57, v57
    v_mfma_f32_32x32x16_bf16 v[80:95], v[20:23], v[68:71], v[80:95]
    v_exp_f32 v58, v58
    v_cvt_pk_bf16_f32 v76, v56, v57
    v_exp_f32 v59, v59
    v_exp_f32 v60, v60
    v_cvt_pk_bf16_f32 v77, v58, v59
    v_exp_f32 v61, v61
    v_exp_f32 v62, v62
    v_exp_f32 v63, v63
    v_cvt_pk_bf16_f32 v78, v60, v61
    v_cvt_pk_bf16_f32 v79, v62, v63
    s_waitcnt lgkmcnt(0)
    v_mfma_f32_32x32x16_bf16 v[48:63], v[12:15], v[4:7], 0
    ds_read_b128 v[8:11], v96 offset:57344
    s_mov_b64 exec, s[14:15]
    ds_read_b128 v[16:19], v97 offset:55296
    ds_read_b128 v[20:23], v97 offset:55808
    s_mov_b64 exec, -1
    v_exp_f32 v32, v32
    v_exp_f32 v33, v33
    v_exp_f32 v34, v34
    v_cvt_pk_bf16_f32 v64, v32, v33
    v_exp_f32 v35, v35
    v_mfma_f32_32x32x16_bf16 v[80:95], v[24:27], v[72:75], v[80:95]
    buffer_load_dwordx4 v[236:239], v3, s[32:35], s24 offen offset:3072 sc1
    s_add_u32 s24, s24, 4096
    v_exp_f32 v36, v36
    v_cvt_pk_bf16_f32 v65, v34, v35
    v_exp_f32 v37, v37
    v_exp_f32 v38, v38
    v_cvt_pk_bf16_f32 v66, v36, v37
    v_exp_f32 v39, v39
    v_exp_f32 v40, v40
    v_cvt_pk_bf16_f32 v67, v38, v39
    v_exp_f32 v41, v41
    v_mfma_f32_32x32x16_bf16 v[80:95], v[28:31], v[76:79], v[80:95]
    v_exp_f32 v42, v42
    v_cvt_pk_bf16_f32 v68, v40, v41
    v_exp_f32 v43, v43
    v_exp_f32 v44, v44
    v_cvt_pk_bf16_f32 v69, v42, v43
    v_exp_f32 v45, v45
    v_exp_f32 v46, v46
    v_exp_f32 v47, v47
    v_cvt_pk_bf16_f32 v70, v44, v45
    v_cvt_pk_bf16_f32 v71, v46, v47
    s_waitcnt lgkmcnt(0)
    v_mfma_f32_32x32x16_bf16 v[32:47], v[8:11], v[4:7], 0
    ds_read_b128 v[12:15], v96 offset:58368
    s_mov_b64 exec, s[14:15]
    ds_read_b128 v[24:27], v97 offset:56320
    ds_read_b128 v[28:31], v97 offset:56832
    s_mov_b64 exec, -1
    v_exp_f32 v48, v48
    v_exp_f32 v49, v49
    v_exp_f32 v50, v50
    v_cvt_pk_bf16_f32 v72, v48, v49
    v_exp_f32 v51, v51
    v_mfma_f32_32x32x16_bf16 v[80:95], v[16:19], v[64:67], v[80:95]
    v_lshrrev_b32 v107, 5, v2
    v_lshlrev_b32 v107, 16, v107
    v_and_b32 v106, 31, v2
    v_lshl_add_u32 v107, v106, 2, v107
    s_lshl_b32 s25, s62, 7
    s_add_u32 s25, s25, 0x10000
    buffer_load_dword v240, v107, s[32:35], s25 offen sc1
    s_add_u32 s25, s25, 8192
    v_exp_f32 v52, v52
    v_cvt_pk_bf16_f32 v73, v50, v51
    v_exp_f32 v53, v53
    v_exp_f32 v54, v54
    v_cvt_pk_bf16_f32 v74, v52, v53
    v_exp_f32 v55, v55
    v_exp_f32 v56, v56
    v_cvt_pk_bf16_f32 v75, v54, v55
    v_exp_f32 v57, v57
    v_mfma_f32_32x32x16_bf16 v[80:95], v[20:23], v[68:71], v[80:95]
    v_exp_f32 v58, v58
    v_cvt_pk_bf16_f32 v76, v56, v57
    v_exp_f32 v59, v59
    v_exp_f32 v60, v60
    v_cvt_pk_bf16_f32 v77, v58, v59
    v_exp_f32 v61, v61
    v_exp_f32 v62, v62
    v_exp_f32 v63, v63
    v_cvt_pk_bf16_f32 v78, v60, v61
    v_cvt_pk_bf16_f32 v79, v62, v63
    s_setprio 0
    s_waitcnt lgkmcnt(0)
    v_mfma_f32_32x32x16_bf16 v[48:63], v[12:15], v[4:7], 0
    ds_read_b128 v[8:11], v96 offset:59392
    s_mov_b64 exec, s[14:15]
    ds_read_b128 v[16:19], v97 offset:57344
    ds_read_b128 v[20:23], v97 offset:57856
    s_mov_b64 exec, -1
    v_exp_f32 v32, v32
    v_exp_f32 v33, v33
    v_exp_f32 v34, v34
    v_cvt_pk_bf16_f32 v64, v32, v33
    v_exp_f32 v35, v35
    v_mfma_f32_32x32x16_bf16 v[80:95], v[24:27], v[72:75], v[80:95]
    buffer_load_dword v241, v107, s[32:35], s25 offen sc1
    s_add_u32 s25, s25, 8192
    v_exp_f32 v36, v36
    v_cvt_pk_bf16_f32 v65, v34, v35
    v_exp_f32 v37, v37
    v_exp_f32 v38, v38
    v_cvt_pk_bf16_f32 v66, v36, v37
    v_exp_f32 v39, v39
    v_exp_f32 v40, v40
    v_cvt_pk_bf16_f32 v67, v38, v39
    v_exp_f32 v41, v41
    v_mfma_f32_32x32x16_bf16 v[80:95], v[28:31], v[76:79], v[80:95]
    v_exp_f32 v42, v42
    v_cvt_pk_bf16_f32 v68, v40, v41
    v_exp_f32 v43, v43
    v_exp_f32 v44, v44
    v_cvt_pk_bf16_f32 v69, v42, v43
    v_exp_f32 v45, v45
    v_exp_f32 v46, v46
    v_exp_f32 v47, v47
    v_cvt_pk_bf16_f32 v70, v44, v45
    v_cvt_pk_bf16_f32 v71, v46, v47
    s_waitcnt lgkmcnt(0)
    v_mfma_f32_32x32x16_bf16 v[32:47], v[8:11], v[4:7], 0
    ds_read_b128 v[12:15], v96 offset:60416
    s_mov_b64 exec, s[14:15]
    ds_read_b128 v[24:27], v97 offset:58368
    ds_read_b128 v[28:31], v97 offset:58880
    s_mov_b64 exec, -1
    v_exp_f32 v48, v48
    v_exp_f32 v49, v49
    v_exp_f32 v50, v50
    v_cvt_pk_bf16_f32 v72, v48, v49
    v_exp_f32 v51, v51
    v_mfma_f32_32x32x16_bf16 v[80:95], v[16:19], v[64:67], v[80:95]
    buffer_load_dword v242, v107, s[32:35], s25 offen sc1
    s_add_u32 s25, s25, 8192
    v_exp_f32 v52, v52
    v_cvt_pk_bf16_f32 v73, v50, v51
    v_exp_f32 v53, v53
    v_exp_f32 v54, v54
    v_cvt_pk_bf16_f32 v74, v52, v53
    v_exp_f32 v55, v55
    v_exp_f32 v56, v56
    v_cvt_pk_bf16_f32 v75, v54, v55
    v_exp_f32 v57, v57
    v_mfma_f32_32x32x16_bf16 v[80:95], v[20:23], v[68:71], v[80:95]
    v_exp_f32 v58, v58
    v_cvt_pk_bf16_f32 v76, v56, v57
    v_exp_f32 v59, v59
    v_exp_f32 v60, v60
    v_cvt_pk_bf16_f32 v77, v58, v59
    v_exp_f32 v61, v61
    v_exp_f32 v62, v62
    v_exp_f32 v63, v63
    v_cvt_pk_bf16_f32 v78, v60, v61
    v_cvt_pk_bf16_f32 v79, v62, v63
    s_waitcnt lgkmcnt(0)
    v_mfma_f32_32x32x16_bf16 v[48:63], v[12:15], v[4:7], 0
    ds_read_b128 v[8:11], v96 offset:61440
    s_mov_b64 exec, s[14:15]
    ds_read_b128 v[16:19], v97 offset:59392
    ds_read_b128 v[20:23], v97 offset:59904
    s_mov_b64 exec, -1
    v_exp_f32 v32, v32
    v_exp_f32 v33, v33
    v_exp_f32 v34, v34
    v_cvt_pk_bf16_f32 v64, v32, v33
    v_exp_f32 v35, v35
    v_mfma_f32_32x32x16_bf16 v[80:95], v[24:27], v[72:75], v[80:95]
    buffer_load_dword v243, v107, s[32:35], s25 offen sc1
    s_add_u32 s25, s25, 8192
    v_exp_f32 v36, v36
    v_cvt_pk_bf16_f32 v65, v34, v35
    v_exp_f32 v37, v37
    v_exp_f32 v38, v38
    v_cvt_pk_bf16_f32 v66, v36, v37
    v_exp_f32 v39, v39
    v_exp_f32 v40, v40
    v_cvt_pk_bf16_f32 v67, v38, v39
    v_exp_f32 v41, v41
    v_mfma_f32_32x32x16_bf16 v[80:95], v[28:31], v[76:79], v[80:95]
    v_exp_f32 v42, v42
    v_cvt_pk_bf16_f32 v68, v40, v41
    v_exp_f32 v43, v43
    v_exp_f32 v44, v44
    v_cvt_pk_bf16_f32 v69, v42, v43
    v_exp_f32 v45, v45
    v_exp_f32 v46, v46
    v_exp_f32 v47, v47
    v_cvt_pk_bf16_f32 v70, v44, v45
    v_cvt_pk_bf16_f32 v71, v46, v47
    s_waitcnt lgkmcnt(0)
    v_mfma_f32_32x32x16_bf16 v[32:47], v[8:11], v[4:7], 0
    ds_read_b128 v[12:15], v96 offset:62464
    s_mov_b64 exec, s[14:15]
    ds_read_b128 v[24:27], v97 offset:60416
    ds_read_b128 v[28:31], v97 offset:60928
    s_mov_b64 exec, -1
    v_exp_f32 v48, v48
    v_exp_f32 v49, v49
    v_exp_f32 v50, v50
    v_cvt_pk_bf16_f32 v72, v48, v49
    v_exp_f32 v51, v51
    v_mfma_f32_32x32x16_bf16 v[80:95], v[16:19], v[64:67], v[80:95]
    buffer_load_dword v244, v107, s[32:35], s25 offen sc1
    s_add_u32 s25, s25, 8192
    v_exp_f32 v52, v52
    v_cvt_pk_bf16_f32 v73, v50, v51
    v_exp_f32 v53, v53
    v_exp_f32 v54, v54
    v_cvt_pk_bf16_f32 v74, v52, v53
    v_exp_f32 v55, v55
    v_exp_f32 v56, v56
    v_cvt_pk_bf16_f32 v75, v54, v55
    v_exp_f32 v57, v57
    v_mfma_f32_32x32x16_bf16 v[80:95], v[20:23], v[68:71], v[80:95]
    v_exp_f32 v58, v58
    v_cvt_pk_bf16_f32 v76, v56, v57
    v_exp_f32 v59, v59
    v_exp_f32 v60, v60
    v_cvt_pk_bf16_f32 v77, v58, v59
    v_exp_f32 v61, v61
    v_exp_f32 v62, v62
    v_exp_f32 v63, v63
    v_cvt_pk_bf16_f32 v78, v60, v61
    v_cvt_pk_bf16_f32 v79, v62, v63
    s_waitcnt lgkmcnt(0)
    v_mfma_f32_32x32x16_bf16 v[48:63], v[12:15], v[4:7], 0
    ds_read_b128 v[8:11], v96 offset:63488
    s_mov_b64 exec, s[14:15]
    ds_read_b128 v[16:19], v97 offset:61440
    ds_read_b128 v[20:23], v97 offset:61952
    s_mov_b64 exec, -1
    v_exp_f32 v32, v32
    v_exp_f32 v33, v33
    v_exp_f32 v34, v34
    v_cvt_pk_bf16_f32 v64, v32, v33
    v_exp_f32 v35, v35
    v_mfma_f32_32x32x16_bf16 v[80:95], v[24:27], v[72:75], v[80:95]
    buffer_load_dword v245, v107, s[32:35], s25 offen sc1
    s_add_u32 s25, s25, 8192
    v_exp_f32 v36, v36
    v_cvt_pk_bf16_f32 v65, v34, v35
    v_exp_f32 v37, v37
    v_exp_f32 v38, v38
    v_cvt_pk_bf16_f32 v66, v36, v37
    v_exp_f32 v39, v39
    v_exp_f32 v40, v40
    v_cvt_pk_bf16_f32 v67, v38, v39
    v_exp_f32 v41, v41
    v_mfma_f32_32x32x16_bf16 v[80:95], v[28:31], v[76:79], v[80:95]
    v_exp_f32 v42, v42
    v_cvt_pk_bf16_f32 v68, v40, v41
    v_exp_f32 v43, v43
    v_exp_f32 v44, v44
    v_cvt_pk_bf16_f32 v69, v42, v43
    v_exp_f32 v45, v45
    v_exp_f32 v46, v46
    v_exp_f32 v47, v47
    v_cvt_pk_bf16_f32 v70, v44, v45
    v_cvt_pk_bf16_f32 v71, v46, v47
    s_waitcnt lgkmcnt(0)
    v_mfma_f32_32x32x16_bf16 v[32:47], v[8:11], v[4:7], 0
    ds_read_b128 v[12:15], v96 offset:64512
    s_mov_b64 exec, s[14:15]
    ds_read_b128 v[24:27], v97 offset:62464
    ds_read_b128 v[28:31], v97 offset:62976
    s_mov_b64 exec, -1
    v_exp_f32 v48, v48
    v_exp_f32 v49, v49
    v_exp_f32 v50, v50
    v_cvt_pk_bf16_f32 v72, v48, v49
    v_exp_f32 v51, v51
    v_mfma_f32_32x32x16_bf16 v[80:95], v[16:19], v[64:67], v[80:95]
    buffer_load_dword v246, v107, s[32:35], s25 offen sc1
    s_add_u32 s25, s25, 8192
    v_exp_f32 v52, v52
    v_cvt_pk_bf16_f32 v73, v50, v51
    v_exp_f32 v53, v53
    v_exp_f32 v54, v54
    v_cvt_pk_bf16_f32 v74, v52, v53
    v_exp_f32 v55, v55
    v_exp_f32 v56, v56
    v_cvt_pk_bf16_f32 v75, v54, v55
    v_exp_f32 v57, v57
    v_mfma_f32_32x32x16_bf16 v[80:95], v[20:23], v[68:71], v[80:95]
    v_exp_f32 v58, v58
    v_cvt_pk_bf16_f32 v76, v56, v57
    v_exp_f32 v59, v59
    v_exp_f32 v60, v60
    v_cvt_pk_bf16_f32 v77, v58, v59
    v_exp_f32 v61, v61
    v_exp_f32 v62, v62
    v_exp_f32 v63, v63
    v_cvt_pk_bf16_f32 v78, v60, v61
    v_cvt_pk_bf16_f32 v79, v62, v63
    s_waitcnt lgkmcnt(0)
    v_mfma_f32_32x32x16_bf16 v[48:63], v[12:15], v[4:7], 0
    s_mov_b64 exec, s[14:15]
    ds_read_b128 v[16:19], v97 offset:63488
    ds_read_b128 v[20:23], v97 offset:64000
    s_mov_b64 exec, -1
    v_exp_f32 v32, v32
    v_exp_f32 v33, v33
    v_exp_f32 v34, v34
    v_cvt_pk_bf16_f32 v64, v32, v33
    v_exp_f32 v35, v35
    v_mfma_f32_32x32x16_bf16 v[80:95], v[24:27], v[72:75], v[80:95]
    buffer_load_dword v247, v107, s[32:35], s25 offen sc1
    v_exp_f32 v36, v36
    v_cvt_pk_bf16_f32 v65, v34, v35
    v_exp_f32 v37, v37
    v_exp_f32 v38, v38
    v_cvt_pk_bf16_f32 v66, v36, v37
    v_exp_f32 v39, v39
    v_exp_f32 v40, v40
    v_cvt_pk_bf16_f32 v67, v38, v39
    v_exp_f32 v41, v41
    v_mfma_f32_32x32x16_bf16 v[80:95], v[28:31], v[76:79], v[80:95]
    v_exp_f32 v42, v42
    v_cvt_pk_bf16_f32 v68, v40, v41
    v_exp_f32 v43, v43
    v_exp_f32 v44, v44
    v_cvt_pk_bf16_f32 v69, v42, v43
    v_exp_f32 v45, v45
    v_exp_f32 v46, v46
    v_exp_f32 v47, v47
    v_cvt_pk_bf16_f32 v70, v44, v45
    v_cvt_pk_bf16_f32 v71, v46, v47
    s_waitcnt lgkmcnt(0)
    s_mov_b64 exec, s[14:15]
    ds_read_b128 v[24:27], v97 offset:64512
    ds_read_b128 v[28:31], v97 offset:65024
    s_mov_b64 exec, -1
    v_exp_f32 v48, v48
    v_exp_f32 v49, v49
    v_exp_f32 v50, v50
    v_cvt_pk_bf16_f32 v72, v48, v49
    v_exp_f32 v51, v51
    v_mfma_f32_32x32x16_bf16 v[80:95], v[16:19], v[64:67], v[80:95]
    v_exp_f32 v52, v52
    v_cvt_pk_bf16_f32 v73, v50, v51
    v_exp_f32 v53, v53
    v_exp_f32 v54, v54
    v_cvt_pk_bf16_f32 v74, v52, v53
    v_exp_f32 v55, v55
    v_exp_f32 v56, v56
    v_cvt_pk_bf16_f32 v75, v54, v55
    v_exp_f32 v57, v57
    v_mfma_f32_32x32x16_bf16 v[80:95], v[20:23], v[68:71], v[80:95]
    v_exp_f32 v58, v58
    v_cvt_pk_bf16_f32 v76, v56, v57
    v_exp_f32 v59, v59
    v_exp_f32 v60, v60
    v_cvt_pk_bf16_f32 v77, v58, v59
    v_exp_f32 v61, v61
    v_exp_f32 v62, v62
    v_exp_f32 v63, v63
    v_cvt_pk_bf16_f32 v78, v60, v61
    v_cvt_pk_bf16_f32 v79, v62, v63
    s_waitcnt lgkmcnt(0)
    v_mfma_f32_32x32x16_bf16 v[80:95], v[24:27], v[72:75], v[80:95]
    v_mfma_f32_32x32x16_bf16 v[80:95], v[28:31], v[76:79], v[80:95]
L_att_fin:
    s_nop 10
    s_nop 0
    v_rcp_f32 v100, v88
    s_nop 0
    v_mul_f32 v80, v100, v80
    v_mul_f32 v81, v100, v81
    v_mul_f32 v82, v100, v82
    v_mul_f32 v83, v100, v83
    v_mul_f32 v84, v100, v84
    v_mul_f32 v85, v100, v85
    v_mul_f32 v86, v100, v86
    v_mul_f32 v87, v100, v87
    v_cvt_pk_bf16_f32 v104, v80, v81
    v_cvt_pk_bf16_f32 v105, v82, v83
    v_cvt_pk_bf16_f32 v106, v84, v85
    v_cvt_pk_bf16_f32 v107, v86, v87
    s_lshl_b32 s56, s64, 3
    s_add_u32 s56, s56, s48
    s_lshl_b32 s56, s56, 5
    s_add_u32 s56, s56, s63
    s_lshl_b32 s56, s56, 10
    s_add_u32 s56, s56, 0x800000
    buffer_store_dwordx4 v[104:107], v3, s[32:35], s56 offen sc1
    s_waitcnt vmcnt(1)
    s_barrier
    s_add_u32 m0, s3, 65536
    s_mov_b32 s57, 196608
    buffer_load_dwordx4 v112, s[36:39], s57 offen lds
    s_add_u32 m0, s3, 66560
    s_mov_b32 s57, 204800
    buffer_load_dwordx4 v112, s[36:39], s57 offen lds
    s_add_u32 m0, s3, 67584
    s_mov_b32 s57, 212992
    buffer_load_dwordx4 v112, s[36:39], s57 offen lds
    s_add_u32 m0, s3, 68608
    s_mov_b32 s57, 221184
    buffer_load_dwordx4 v112, s[36:39], s57 offen lds
    v_lshrrev_b32 v100, 5, v2
    v_lshlrev_b32 v100, 3, v100
    v_bfe_u32 v101, v2, 2, 2
    v_add_u32 v100, v100, v101
    v_lshlrev_b32 v100, 7, v100
    v_and_b32 v101, 1, v2
    v_lshlrev_b32 v101, 2, v101
    v_bfe_u32 v102, v2, 4, 1
    v_lshl_add_u32 v101, v102, 1, v101
    v_bfe_u32 v102, v2, 1, 1
    v_add_u32 v101, v101, v102
    v_lshl_add_u32 v100, v101, 3, v100
    s_lshl_b32 s56, s10, 13
    v_add_u32 v100, s56, v100
    v_bfe_u32 v102, v2, 3, 1
    v_lshlrev_b32 v102, 6, v102
    v_add_u32 v6, v100, v102
    v_xor_b32 v102, 64, v102
    v_add_u32 v7, v100, v102
    v_add_u32 v8, 0x10000, v6
    v_add_u32 v108, 0x20000, v6
    v_add_u32 v9, 0x10000, v7
    v_add_u32 v109, 0x20000, v7
    ds_read_b64_tr_b16 v[16:17], v6 offset:32768
    ds_read_b64_tr_b16 v[18:19], v6 offset:33280
    ds_read_b64_tr_b16 v[20:21], v7 offset:32768
    ds_read_b64_tr_b16 v[22:23], v7 offset:33280
    s_waitcnt lgkmcnt(2)
    v_mfma_f32_32x32x16_bf16 v[32:47], v[16:19], v[128:131], 0
    ds_read_b64_tr_b16 v[24:25], v6 offset:34816
    ds_read_b64_tr_b16 v[26:27], v6 offset:35328
    s_add_u32 m0, s3, 131072
    s_mov_b32 s57, 262144
    buffer_load_dwordx4 v112, s[36:39], s57 offen lds
    s_add_u32 m0, s3, 132096
    s_mov_b32 s57, 270336
    buffer_load_dwordx4 v112, s[36:39], s57 offen lds
    s_waitcnt lgkmcnt(2)
    v_mfma_f32_32x32x16_bf16 v[48:63], v[20:23], v[128:131], 0
    ds_read_b64_tr_b16 v[28:29], v7 offset:34816
    ds_read_b64_tr_b16 v[30:31], v7 offset:35328
    s_waitcnt lgkmcnt(2)
    v_mfma_f32_32x32x16_bf16 v[32:47], v[24:27], v[132:135], v[32:47]
    ds_read_b64_tr_b16 v[16:17], v6 offset:36864
    ds_read_b64_tr_b16 v[18:19], v6 offset:37376
    s_add_u32 m0, s3, 133120
    s_mov_b32 s57, 278528
    buffer_load_dwordx4 v112, s[36:39], s57 offen lds
    s_add_u32 m0, s3, 134144
    s_mov_b32 s57, 286720
    buffer_load_dwordx4 v112, s[36:39], s57 offen lds
    s_waitcnt lgkmcnt(2)
    v_mfma_f32_32x32x16_bf16 v[48:63], v[28:31], v[132:135], v[48:63]
    ds_read_b64_tr_b16 v[20:21], v7 offset:36864
    ds_read_b64_tr_b16 v[22:23], v7 offset:37376
    s_waitcnt vmcnt(8)
    s_barrier
    s_add_u32 s56, s64, 32
    s_lshl_b32 s56, s56, 8
    v_mov_b32 v100, 0x7fff0000
    v_mov_b32 v101, s56
    v_cmp_eq_u32 vcc, 0, v0
    s_nop 1
    v_cndmask_b32 v100, v100, v101, vcc
    v_mov_b32 v101, 1
    buffer_atomic_add v101, v100, s[32:35], 0 offen sc1
    s_waitcnt lgkmcnt(2)
    v_mfma_f32_32x32x16_bf16 v[32:47], v[16:19], v[136:139], v[32:47]
    ds_read_b64_tr_b16 v[24:25], v6 offset:38912
    ds_read_b64_tr_b16 v[26:27], v6 offset:39424
    s_waitcnt lgkmcnt(2)
    v_mfma_f32_32x32x16_bf16 v[48:63], v[20:23], v[136:139], v[48:63]
    ds_read_b64_tr_b16 v[28:29], v7 offset:38912
    ds_read_b64_tr_b16 v[30:31], v7 offset:39424
    s_waitcnt lgkmcnt(2)
    v_mfma_f32_32x32x16_bf16 v[32:47], v[24:27], v[140:143], v[32:47]
    ds_read_b64_tr_b16 v[16:17], v8 offset:32768
    ds_read_b64_tr_b16 v[18:19], v8 offset:33280
    s_waitcnt lgkmcnt(2)
    v_mfma_f32_32x32x16_bf16 v[48:63], v[28:31], v[140:143], v[48:63]
    ds_read_b64_tr_b16 v[20:21], v9 offset:32768
    ds_read_b64_tr_b16 v[22:23], v9 offset:33280
    s_waitcnt lgkmcnt(2)
    v_mfma_f32_32x32x16_bf16 v[32:47], v[16:19], v[144:147], v[32:47]
    ds_read_b64_tr_b16 v[24:25], v8 offset:34816
    ds_read_b64_tr_b16 v[26:27], v8 offset:35328
    v_add_f32 v240, v240, v241
    v_add_f32 v240, v240, v242
    v_add_f32 v240, v240, v243
    v_add_f32 v240, v240, v244
    v_add_f32 v240, v240, v245
    v_add_f32 v240, v240, v246
    v_add_f32 v240, v240, v247
    v_mov_b32 v241, v240
    s_nop 0
    s_nop 0
    v_permlane32_swap_b32 v240, v241
    v_add_f32 v240, v240, v241
    v_mul_f32 v240, 0xbfb8aa3b, v240
    v_exp_f32 v240, v240
    s_nop 0
    v_add_f32 v240, 1.0, v240
    v_rcp_f32 v10, v240
    s_nop 0
    v_sub_f32 v11, 1.0, v10
    s_waitcnt lgkmcnt(2)
    v_mfma_f32_32x32x16_bf16 v[48:63], v[20:23], v[144:147], v[48:63]
    ds_read_b64_tr_b16 v[28:29], v9 offset:34816
    ds_read_b64_tr_b16 v[30:31], v9 offset:35328
    s_waitcnt lgkmcnt(2)
    v_mfma_f32_32x32x16_bf16 v[32:47], v[24:27], v[148:151], v[32:47]
    ds_read_b64_tr_b16 v[16:17], v8 offset:36864
    ds_read_b64_tr_b16 v[18:19], v8 offset:37376
    s_waitcnt lgkmcnt(2)
    v_mfma_f32_32x32x16_bf16 v[48:63], v[28:31], v[148:151], v[48:63]
    ds_read_b64_tr_b16 v[20:21], v9 offset:36864
    ds_read_b64_tr_b16 v[22:23], v9 offset:37376
    s_barrier
    s_waitcnt lgkmcnt(2)
    v_mfma_f32_32x32x16_bf16 v[32:47], v[16:19], v[152:155], v[32:47]
    ds_read_b64_tr_b16 v[24:25], v8 offset:38912
    ds_read_b64_tr_b16 v[26:27], v8 offset:39424
    s_add_u32 m0, s3, 32768
    s_mov_b32 s57, 327680
    buffer_load_dwordx4 v112, s[36:39], s57 offen lds
    s_waitcnt lgkmcnt(2)
    v_mfma_f32_32x32x16_bf16 v[48:63], v[20:23], v[152:155], v[48:63]
    ds_read_b64_tr_b16 v[28:29], v9 offset:38912
    ds_read_b64_tr_b16 v[30:31], v9 offset:39424
    s_waitcnt lgkmcnt(2)
    v_mfma_f32_32x32x16_bf16 v[32:47], v[24:27], v[156:159], v[32:47]
    ds_read_b64_tr_b16 v[16:17], v6 offset:0
    ds_read_b64_tr_b16 v[18:19], v6 offset:512
    s_add_u32 m0, s3, 33792
    s_mov_b32 s57, 335872
    buffer_load_dwordx4 v112, s[36:39], s57 offen lds
    s_waitcnt lgkmcnt(2)
    v_mfma_f32_32x32x16_bf16 v[48:63], v[28:31], v[156:159], v[48:63]
    ds_read_b64_tr_b16 v[20:21], v7 offset:0
    ds_read_b64_tr_b16 v[22:23], v7 offset:512
    s_waitcnt lgkmcnt(2)
    v_mfma_f32_32x32x16_bf16 v[32:47], v[16:19], v[160:163], v[32:47]
    ds_read_b64_tr_b16 v[24:25], v6 offset:2048
    ds_read_b64_tr_b16 v[26:27], v6 offset:2560
    s_add_u32 m0, s3, 34816
    s_mov_b32 s57, 344064
    buffer_load_dwordx4 v112, s[36:39], s57 offen lds
    v_and_b32 v100, 31, v2
    v_and_b32 v101, 15, v2
    v_lshrrev_b32 v102, 5, v2
    v_lshlrev_b32 v102, 2, v102
    v_xor_b32 v101, v101, v102
    v_lshlrev_b32 v101, 4, v101
    v_lshl_add_u32 v100, v100, 8, v101
    s_lshl_b32 s56, s48, 13
    v_add_u32 v114, s56, v100
    s_waitcnt lgkmcnt(2)
    v_mfma_f32_32x32x16_bf16 v[48:63], v[20:23], v[160:163], v[48:63]
    ds_read_b64_tr_b16 v[28:29], v7 offset:2048
    ds_read_b64_tr_b16 v[30:31], v7 offset:2560
    s_waitcnt lgkmcnt(2)
    v_mfma_f32_32x32x16_bf16 v[32:47], v[24:27], v[164:167], v[32:47]
    ds_read_b64_tr_b16 v[16:17], v6 offset:4096
    ds_read_b64_tr_b16 v[18:19], v6 offset:4608
    s_add_u32 m0, s3, 35840
    s_mov_b32 s57, 352256
    buffer_load_dwordx4 v112, s[36:39], s57 offen lds
    s_add_u32 s56, s54, 32
    s_lshl_b32 s56, s56, 8
    v_mov_b32 v107, s56
    s_waitcnt lgkmcnt(2)
    v_mfma_f32_32x32x16_bf16 v[48:63], v[28:31], v[164:167], v[48:63]
    ds_read_b64_tr_b16 v[20:21], v7 offset:4096
    ds_read_b64_tr_b16 v[22:23], v7 offset:4608
    s_waitcnt vmcnt(9)
    s_barrier
    s_waitcnt lgkmcnt(2)
    v_mfma_f32_32x32x16_bf16 v[32:47], v[16:19], v[168:171], v[32:47]
    ds_read_b64_tr_b16 v[24:25], v6 offset:6144
    ds_read_b64_tr_b16 v[26:27], v6 offset:6656
    s_add_u32 m0, s3, 98304
    s_mov_b32 s57, 393216
    buffer_load_dwordx4 v112, s[36:39], s57 offen lds
    s_waitcnt lgkmcnt(2)
    v_mfma_f32_32x32x16_bf16 v[48:63], v[20:23], v[168:171], v[48:63]
    ds_read_b64_tr_b16 v[28:29], v7 offset:6144
    ds_read_b64_tr_b16 v[30:31], v7 offset:6656
    s_waitcnt lgkmcnt(2)
    v_mfma_f32_32x32x16_bf16 v[32:47], v[24:27], v[172:175], v[32:47]
    ds_read_b64_tr_b16 v[16:17], v8 offset:0
    ds_read_b64_tr_b16 v[18:19], v8 offset:512
    s_add_u32 m0, s3, 99328
    s_mov_b32 s57, 401408
    buffer_load_dwordx4 v112, s[36:39], s57 offen lds
    s_waitcnt lgkmcnt(2)
    v_mfma_f32_32x32x16_bf16 v[48:63], v[28:31], v[172:175], v[48:63]
    ds_read_b64_tr_b16 v[20:21], v9 offset:0
    ds_read_b64_tr_b16 v[22:23], v9 offset:512
    s_waitcnt lgkmcnt(2)
    v_mfma_f32_32x32x16_bf16 v[32:47], v[16:19], v[176:179], v[32:47]
    ds_read_b64_tr_b16 v[24:25], v8 offset:2048
    ds_read_b64_tr_b16 v[26:27], v8 offset:2560
    s_add_u32 m0, s3, 100352
    s_mov_b32 s57, 409600
    buffer_load_dwordx4 v112, s[36:39], s57 offen lds
    v_lshrrev_b32 v100, 3, v2
    s_lshl_b32 s56, s10, 3
    v_add_u32 v100, s56, v100
    v_and_b32 v101, 7, v2
    v_lshlrev_b32 v101, 1, v101
    v_and_b32 v102, 15, v100
    v_xor_b32 v101, v101, v102
    v_lshlrev_b32 v101, 4, v101
    v_lshl_add_u32 v101, v100, 8, v101
    s_lshl_b32 s56, s11, 13
    v_add_u32 v115, s56, v101
    v_xor_b32 v116, 16, v115
    s_lshl_b32 s56, s62, 5
    v_add_u32 v100, s56, v100
    v_and_b32 v103, 7, v2
    v_lshlrev_b32 v103, 4, v103
    v_lshl_add_u32 v100, v100, 10, v103
    s_lshl_b32 s56, s68, 7
    v_add_u32 v117, s56, v100
    s_mov_b32 s44, s20
    s_mov_b32 s45, s21
    s_mov_b32 s46, 0x200000
    s_mov_b32 s47, 0x20000
    s_waitcnt lgkmcnt(2)
    v_mfma_f32_32x32x16_bf16 v[48:63], v[20:23], v[176:179], v[48:63]
    ds_read_b64_tr_b16 v[28:29], v9 offset:2048
    ds_read_b64_tr_b16 v[30:31], v9 offset:2560
    s_waitcnt lgkmcnt(2)
    v_mfma_f32_32x32x16_bf16 v[32:47], v[24:27], v[180:183], v[32:47]
    ds_read_b64_tr_b16 v[16:17], v8 offset:4096
    ds_read_b64_tr_b16 v[18:19], v8 offset:4608
    s_add_u32 m0, s3, 101376
    s_mov_b32 s57, 417792
    buffer_load_dwordx4 v112, s[36:39], s57 offen lds
    s_waitcnt lgkmcnt(2)
    v_mfma_f32_32x32x16_bf16 v[48:63], v[28:31], v[180:183], v[48:63]
    ds_read_b64_tr_b16 v[20:21], v9 offset:4096
    ds_read_b64_tr_b16 v[22:23], v9 offset:4608
    s_waitcnt vmcnt(9)
    s_barrier
    s_waitcnt lgkmcnt(2)
    v_mfma_f32_32x32x16_bf16 v[32:47], v[16:19], v[184:187], v[32:47]
    ds_read_b64_tr_b16 v[24:25], v8 offset:6144
    ds_read_b64_tr_b16 v[26:27], v8 offset:6656
    s_add_u32 m0, s3, 0
    s_mov_b32 s57, 0
    buffer_load_dwordx4 v113, s[28:31], s57 offen lds
    s_waitcnt lgkmcnt(2)
    v_mfma_f32_32x32x16_bf16 v[48:63], v[20:23], v[184:187], v[48:63]
    ds_read_b64_tr_b16 v[28:29], v9 offset:6144
    ds_read_b64_tr_b16 v[30:31], v9 offset:6656
    s_waitcnt lgkmcnt(2)
    v_mfma_f32_32x32x16_bf16 v[32:47], v[24:27], v[188:191], v[32:47]
    ds_read_b64_tr_b16 v[16:17], v108 offset:0
    ds_read_b64_tr_b16 v[18:19], v108 offset:512
    s_add_u32 m0, s3, 1024
    s_mov_b32 s57, 8192
    buffer_load_dwordx4 v113, s[28:31], s57 offen lds
    s_waitcnt lgkmcnt(2)
    v_mfma_f32_32x32x16_bf16 v[48:63], v[28:31], v[188:191], v[48:63]
    ds_read_b64_tr_b16 v[20:21], v109 offset:0
    ds_read_b64_tr_b16 v[22:23], v109 offset:512
    s_waitcnt lgkmcnt(2)
    v_mfma_f32_32x32x16_bf16 v[32:47], v[16:19], v[192:195], v[32:47]
    ds_read_b64_tr_b16 v[24:25], v108 offset:2048
    ds_read_b64_tr_b16 v[26:27], v108 offset:2560
    s_add_u32 m0, s3, 2048
    s_mov_b32 s57, 16384
    buffer_load_dwordx4 v113, s[28:31], s57 offen lds
    s_waitcnt lgkmcnt(2)
    v_mfma_f32_32x32x16_bf16 v[48:63], v[20:23], v[192:195], v[48:63]
    ds_read_b64_tr_b16 v[28:29], v109 offset:2048
    ds_read_b64_tr_b16 v[30:31], v109 offset:2560
    s_waitcnt lgkmcnt(2)
    v_mfma_f32_32x32x16_bf16 v[32:47], v[24:27], v[196:199], v[32:47]
    ds_read_b64_tr_b16 v[16:17], v108 offset:4096
    ds_read_b64_tr_b16 v[18:19], v108 offset:4608
    s_add_u32 m0, s3, 3072
    s_mov_b32 s57, 24576
    buffer_load_dwordx4 v113, s[28:31], s57 offen lds
    s_waitcnt lgkmcnt(2)
    v_mfma_f32_32x32x16_bf16 v[48:63], v[28:31], v[196:199], v[48:63]
    ds_read_b64_tr_b16 v[20:21], v109 offset:4096
    ds_read_b64_tr_b16 v[22:23], v109 offset:4608
    s_waitcnt vmcnt(8)
    s_barrier
    buffer_load_dword v106, v107, s[32:35], 0 offen sc1
    s_waitcnt lgkmcnt(2)
    v_mfma_f32_32x32x16_bf16 v[32:47], v[16:19], v[200:203], v[32:47]
    ds_read_b64_tr_b16 v[24:25], v108 offset:6144
    ds_read_b64_tr_b16 v[26:27], v108 offset:6656
    s_add_u32 m0, s3, 65536
    s_mov_b32 s57, 65536
    buffer_load_dwordx4 v113, s[28:31], s57 offen lds
    s_waitcnt lgkmcnt(2)
    v_mfma_f32_32x32x16_bf16 v[48:63], v[20:23], v[200:203], v[48:63]
    ds_read_b64_tr_b16 v[28:29], v109 offset:6144
    ds_read_b64_tr_b16 v[30:31], v109 offset:6656
    s_waitcnt lgkmcnt(2)
    v_mfma_f32_32x32x16_bf16 v[32:47], v[24:27], v[204:207], v[32:47]
    ds_read_b64_tr_b16 v[16:17], v6 offset:32768
    ds_read_b64_tr_b16 v[18:19], v6 offset:33280
    s_add_u32 m0, s3, 66560
    s_mov_b32 s57, 73728
    buffer_load_dwordx4 v113, s[28:31], s57 offen lds
    s_waitcnt lgkmcnt(2)
    v_mfma_f32_32x32x16_bf16 v[48:63], v[28:31], v[204:207], v[48:63]
    ds_read_b64_tr_b16 v[20:21], v7 offset:32768
    ds_read_b64_tr_b16 v[22:23], v7 offset:33280
    s_waitcnt lgkmcnt(2)
    v_mfma_f32_32x32x16_bf16 v[32:47], v[16:19], v[208:211], v[32:47]
    ds_read_b64_tr_b16 v[24:25], v6 offset:34816
    ds_read_b64_tr_b16 v[26:27], v6 offset:35328
    s_add_u32 m0, s3, 67584
    s_mov_b32 s57, 81920
    buffer_load_dwordx4 v113, s[28:31], s57 offen lds
    s_waitcnt lgkmcnt(2)
    v_mfma_f32_32x32x16_bf16 v[48:63], v[20:23], v[208:211], v[48:63]
    ds_read_b64_tr_b16 v[28:29], v7 offset:34816
    ds_read_b64_tr_b16 v[30:31], v7 offset:35328
    s_waitcnt lgkmcnt(2)
    v_mfma_f32_32x32x16_bf16 v[32:47], v[24:27], v[212:215], v[32:47]
    ds_read_b64_tr_b16 v[16:17], v6 offset:36864
    ds_read_b64_tr_b16 v[18:19], v6 offset:37376
    s_add_u32 m0, s3, 68608
    s_mov_b32 s57, 90112
    buffer_load_dwordx4 v113, s[28:31], s57 offen lds
    s_waitcnt lgkmcnt(2)
    v_mfma_f32_32x32x16_bf16 v[48:63], v[28:31], v[212:215], v[48:63]
    ds_read_b64_tr_b16 v[20:21], v7 offset:36864
    ds_read_b64_tr_b16 v[22:23], v7 offset:37376
    s_waitcnt vmcnt(4)
    s_cmp_eq_u32 s48, 0
    s_cbranch_scc0 L_ok17
    v_readfirstlane_b32 s56, v106
    s_nop 0
    s_cmp_ge_u32 s56, 32
    s_cbranch_scc1 L_ok17
    s_mov_b32 s66, 0
L_poll17:
    buffer_load_dword v106, v107, s[32:35], 0 offen sc1
    s_waitcnt vmcnt(0)
    v_readfirstlane_b32 s56, v106
    s_add_u32 s66, s66, 1
    s_cmp_ge_u32 s66, 0x80000
    s_cbranch_scc1 L_ok17
    s_cmp_lt_u32 s56, 32
    s_cbranch_scc1 L_poll17
L_ok17:
    s_barrier
    s_lshl_b32 s58, s62, 5
    s_lshl_b32 s57, s10, 3
    s_add_u32 s58, s58, s57
    s_lshl_b32 s58, s58, 10
    s_add_u32 s58, s58, 0x800000
    buffer_load_dwordx4 v[128:131], v3, s[32:35], s58 offen sc1
    buffer_load_dwordx4 v[132:135], v3, s[32:35], s58 offen offset:1024 sc1
    buffer_load_dwordx4 v[136:139], v3, s[32:35], s58 offen offset:2048 sc1
    buffer_load_dwordx4 v[140:143], v3, s[32:35], s58 offen offset:3072 sc1
    s_add_u32 s58, s58, 4096
    buffer_load_dwordx4 v[144:147], v3, s[32:35], s58 offen sc1
    buffer_load_dwordx4 v[148:151], v3, s[32:35], s58 offen offset:1024 sc1
    buffer_load_dwordx4 v[152:155], v3, s[32:35], s58 offen offset:2048 sc1
    buffer_load_dwordx4 v[156:159], v3, s[32:35], s58 offen offset:3072 sc1
    s_waitcnt lgkmcnt(2)
    v_mfma_f32_32x32x16_bf16 v[32:47], v[16:19], v[216:219], v[32:47]
    ds_read_b64_tr_b16 v[24:25], v6 offset:38912
    ds_read_b64_tr_b16 v[26:27], v6 offset:39424
    s_waitcnt lgkmcnt(2)
    v_mfma_f32_32x32x16_bf16 v[48:63], v[20:23], v[216:219], v[48:63]
    ds_read_b64_tr_b16 v[28:29], v7 offset:38912
    ds_read_b64_tr_b16 v[30:31], v7 offset:39424
    s_waitcnt lgkmcnt(2)
    v_mfma_f32_32x32x16_bf16 v[32:47], v[24:27], v[220:223], v[32:47]
    ds_read_b64_tr_b16 v[16:17], v8 offset:32768
    ds_read_b64_tr_b16 v[18:19], v8 offset:33280
    s_waitcnt lgkmcnt(2)
    v_mfma_f32_32x32x16_bf16 v[48:63], v[28:31], v[220:223], v[48:63]
    ds_read_b64_tr_b16 v[20:21], v9 offset:32768
    ds_read_b64_tr_b16 v[22:23], v9 offset:33280
    s_waitcnt lgkmcnt(2)
    v_mfma_f32_32x32x16_bf16 v[32:47], v[16:19], v[224:227], v[32:47]
    ds_read_b64_tr_b16 v[24:25], v8 offset:34816
    ds_read_b64_tr_b16 v[26:27], v8 offset:35328
    s_waitcnt lgkmcnt(2)
    v_mfma_f32_32x32x16_bf16 v[48:63], v[20:23], v[224:227], v[48:63]
    ds_read_b64_tr_b16 v[28:29], v9 offset:34816
    ds_read_b64_tr_b16 v[30:31], v9 offset:35328
    s_waitcnt lgkmcnt(2)
    v_mfma_f32_32x32x16_bf16 v[32:47], v[24:27], v[228:231], v[32:47]
    ds_read_b64_tr_b16 v[16:17], v8 offset:36864
    ds_read_b64_tr_b16 v[18:19], v8 offset:37376
    s_waitcnt lgkmcnt(2)
    v_mfma_f32_32x32x16_bf16 v[48:63], v[28:31], v[228:231], v[48:63]
    ds_read_b64_tr_b16 v[20:21], v9 offset:36864
    ds_read_b64_tr_b16 v[22:23], v9 offset:37376
    s_barrier
    s_waitcnt lgkmcnt(2)
    v_mfma_f32_32x32x16_bf16 v[32:47], v[16:19], v[232:235], v[32:47]
    ds_read_b64_tr_b16 v[24:25], v8 offset:38912
    ds_read_b64_tr_b16 v[26:27], v8 offset:39424
    s_waitcnt lgkmcnt(2)
    v_mfma_f32_32x32x16_bf16 v[48:63], v[20:23], v[232:235], v[48:63]
    ds_read_b64_tr_b16 v[28:29], v9 offset:38912
    ds_read_b64_tr_b16 v[30:31], v9 offset:39424
    s_waitcnt lgkmcnt(2)
    v_mfma_f32_32x32x16_bf16 v[32:47], v[24:27], v[236:239], v[32:47]
    ds_read_b64_tr_b16 v[16:17], v6 offset:0
    ds_read_b64_tr_b16 v[18:19], v6 offset:512
    s_waitcnt lgkmcnt(2)
    v_mfma_f32_32x32x16_bf16 v[48:63], v[28:31], v[236:239], v[48:63]
    ds_read_b64_tr_b16 v[20:21], v7 offset:0
    ds_read_b64_tr_b16 v[22:23], v7 offset:512
    s_waitcnt vmcnt(0)
    s_waitcnt lgkmcnt(2)
    v_mfma_f32_32x32x16_bf16 v[64:79], v[16:19], v[128:131], 0
    ds_read_b64_tr_b16 v[24:25], v6 offset:2048
    ds_read_b64_tr_b16 v[26:27], v6 offset:2560
    s_waitcnt lgkmcnt(2)
    v_mfma_f32_32x32x16_bf16 v[80:95], v[20:23], v[128:131], 0
    ds_read_b64_tr_b16 v[28:29], v7 offset:2048
    ds_read_b64_tr_b16 v[30:31], v7 offset:2560
    s_waitcnt lgkmcnt(2)
    v_mfma_f32_32x32x16_bf16 v[64:79], v[24:27], v[132:135], v[64:79]
    ds_read_b64_tr_b16 v[16:17], v6 offset:4096
    ds_read_b64_tr_b16 v[18:19], v6 offset:4608
    s_waitcnt lgkmcnt(2)
    v_mfma_f32_32x32x16_bf16 v[80:95], v[28:31], v[132:135], v[80:95]
    ds_read_b64_tr_b16 v[20:21], v7 offset:4096
    ds_read_b64_tr_b16 v[22:23], v7 offset:4608
    s_barrier
    s_waitcnt lgkmcnt(2)
    v_mfma_f32_32x32x16_bf16 v[64:79], v[16:19], v[136:139], v[64:79]
    ds_read_b64_tr_b16 v[24:25], v6 offset:6144
    ds_read_b64_tr_b16 v[26:27], v6 offset:6656
    v_mul_f32 v32, v11, v32
    v_mul_f32 v33, v11, v33
    v_mul_f32 v34, v11, v34
    v_mul_f32 v35, v11, v35
    s_waitcnt lgkmcnt(2)
    v_mfma_f32_32x32x16_bf16 v[80:95], v[20:23], v[136:139], v[80:95]
    ds_read_b64_tr_b16 v[28:29], v7 offset:6144
    ds_read_b64_tr_b16 v[30:31], v7 offset:6656
    v_mul_f32 v36, v11, v36
    v_mul_f32 v37, v11, v37
    v_mul_f32 v38, v11, v38
    v_mul_f32 v39, v11, v39
    s_waitcnt lgkmcnt(2)
    v_mfma_f32_32x32x16_bf16 v[64:79], v[24:27], v[140:143], v[64:79]
    ds_read_b64_tr_b16 v[16:17], v8 offset:0
    ds_read_b64_tr_b16 v[18:19], v8 offset:512
    v_mul_f32 v40, v11, v40
    v_mul_f32 v41, v11, v41
    v_mul_f32 v42, v11, v42
    v_mul_f32 v43, v11, v43
    s_waitcnt lgkmcnt(2)
    v_mfma_f32_32x32x16_bf16 v[80:95], v[28:31], v[140:143], v[80:95]
    ds_read_b64_tr_b16 v[20:21], v9 offset:0
    ds_read_b64_tr_b16 v[22:23], v9 offset:512
    v_mul_f32 v44, v11, v44
    v_mul_f32 v45, v11, v45
    v_mul_f32 v46, v11, v46
    v_mul_f32 v47, v11, v47
    s_waitcnt lgkmcnt(2)
    v_mfma_f32_32x32x16_bf16 v[64:79], v[16:19], v[144:147], v[64:79]
    ds_read_b64_tr_b16 v[24:25], v8 offset:2048
    ds_read_b64_tr_b16 v[26:27], v8 offset:2560
    v_mul_f32 v48, v11, v48
    v_mul_f32 v49, v11, v49
    v_mul_f32 v50, v11, v50
    v_mul_f32 v51, v11, v51
    s_waitcnt lgkmcnt(2)
    v_mfma_f32_32x32x16_bf16 v[80:95], v[20:23], v[144:147], v[80:95]
    ds_read_b64_tr_b16 v[28:29], v9 offset:2048
    ds_read_b64_tr_b16 v[30:31], v9 offset:2560
    v_mul_f32 v52, v11, v52
    v_mul_f32 v53, v11, v53
    v_mul_f32 v54, v11, v54
    v_mul_f32 v55, v11, v55
    s_waitcnt lgkmcnt(2)
    v_mfma_f32_32x32x16_bf16 v[64:79], v[24:27], v[148:151], v[64:79]
    ds_read_b64_tr_b16 v[16:17], v8 offset:4096
    ds_read_b64_tr_b16 v[18:19], v8 offset:4608
    v_mul_f32 v56, v11, v56
    v_mul_f32 v57, v11, v57
    v_mul_f32 v58, v11, v58
    v_mul_f32 v59, v11, v59
    s_waitcnt lgkmcnt(2)
    v_mfma_f32_32x32x16_bf16 v[80:95], v[28:31], v[148:151], v[80:95]
    ds_read_b64_tr_b16 v[20:21], v9 offset:4096
    ds_read_b64_tr_b16 v[22:23], v9 offset:4608
    v_mul_f32 v60, v11, v60
    v_mul_f32 v61, v11, v61
    v_mul_f32 v62, v11, v62
    v_mul_f32 v63, v11, v63
    s_barrier
    s_waitcnt lgkmcnt(2)
    v_mfma_f32_32x32x16_bf16 v[64:79], v[16:19], v[152:155], v[64:79]
    ds_read_b64_tr_b16 v[24:25], v8 offset:6144
    ds_read_b64_tr_b16 v[26:27], v8 offset:6656
    s_waitcnt lgkmcnt(2)
    v_mfma_f32_32x32x16_bf16 v[80:95], v[20:23], v[152:155], v[80:95]
    ds_read_b64_tr_b16 v[28:29], v9 offset:6144
    ds_read_b64_tr_b16 v[30:31], v9 offset:6656
    s_waitcnt lgkmcnt(2)
    v_mfma_f32_32x32x16_bf16 v[64:79], v[24:27], v[156:159], v[64:79]
    s_waitcnt lgkmcnt(0)
    v_mfma_f32_32x32x16_bf16 v[80:95], v[28:31], v[156:159], v[80:95]
    s_nop 1
    s_nop 7
    v_fmac_f32 v32, v10, v64
    v_fmac_f32 v33, v10, v65
    v_fmac_f32 v34, v10, v66
    v_fmac_f32 v35, v10, v67
    v_xor_b32 v101, 0, v114
    ds_write_b128 v101, v[32:35]
    v_fmac_f32 v36, v10, v68
    v_fmac_f32 v37, v10, v69
    v_fmac_f32 v38, v10, v70
    v_fmac_f32 v39, v10, v71
    v_xor_b32 v102, 16, v114
    ds_write_b128 v102, v[36:39]
    v_fmac_f32 v40, v10, v72
    v_fmac_f32 v41, v10, v73
    v_fmac_f32 v42, v10, v74
    v_fmac_f32 v43, v10, v75
    v_xor_b32 v101, 32, v114
    ds_write_b128 v101, v[40:43]
    v_fmac_f32 v44, v10, v76
    v_fmac_f32 v45, v10, v77
    v_fmac_f32 v46, v10, v78
    v_fmac_f32 v47, v10, v79
    v_xor_b32 v102, 48, v114
    ds_write_b128 v102, v[44:47]
    v_fmac_f32 v48, v10, v80
    v_fmac_f32 v49, v10, v81
    v_fmac_f32 v50, v10, v82
    v_fmac_f32 v51, v10, v83
    v_xor_b32 v101, 128, v114
    ds_write_b128 v101, v[48:51]
    v_fmac_f32 v52, v10, v84
    v_fmac_f32 v53, v10, v85
    v_fmac_f32 v54, v10, v86
    v_fmac_f32 v55, v10, v87
    v_xor_b32 v102, 144, v114
    ds_write_b128 v102, v[52:55]
    v_fmac_f32 v56, v10, v88
    v_fmac_f32 v57, v10, v89
    v_fmac_f32 v58, v10, v90
    v_fmac_f32 v59, v10, v91
    v_xor_b32 v101, 160, v114
    ds_write_b128 v101, v[56:59]
    v_fmac_f32 v60, v10, v92
    v_fmac_f32 v61, v10, v93
    v_fmac_f32 v62, v10, v94
    v_fmac_f32 v63, v10, v95
    v_xor_b32 v102, 176, v114
    ds_write_b128 v102, v[60:63]
    s_waitcnt lgkmcnt(0)
    s_barrier
    ds_read_b128 v[16:19], v115 offset:0
    ds_read_b128 v[20:23], v116 offset:0
    ds_read_b128 v[24:27], v115 offset:16384
    ds_read_b128 v[28:31], v116 offset:16384
    ds_read_b128 v[32:35], v115 offset:32768
    ds_read_b128 v[36:39], v116 offset:32768
    ds_read_b128 v[40:43], v115 offset:49152
    ds_read_b128 v[44:47], v116 offset:49152
    s_waitcnt lgkmcnt(4)
    v_add_f32 v16, v16, v24
    v_add_f32 v17, v17, v25
    v_add_f32 v18, v18, v26
    v_add_f32 v19, v19, v27
    v_add_f32 v20, v20, v28
    v_add_f32 v21, v21, v29
    v_add_f32 v22, v22, v30
    v_add_f32 v23, v23, v31
    s_waitcnt lgkmcnt(0)
    v_add_f32 v32, v32, v40
    v_add_f32 v33, v33, v41
    v_add_f32 v34, v34, v42
    v_add_f32 v35, v35, v43
    v_add_f32 v36, v36, v44
    v_add_f32 v37, v37, v45
    v_add_f32 v38, v38, v46
    v_add_f32 v39, v39, v47
    v_add_f32 v16, v16, v32
    v_add_f32 v17, v17, v33
    v_add_f32 v18, v18, v34
    v_add_f32 v19, v19, v35
    v_add_f32 v20, v20, v36
    v_add_f32 v21, v21, v37
    v_add_f32 v22, v22, v38
    v_add_f32 v23, v23, v39
    v_cvt_pk_bf16_f32 v24, v16, v17
    v_cvt_pk_bf16_f32 v25, v18, v19
    v_cvt_pk_bf16_f32 v26, v20, v21
    v_cvt_pk_bf16_f32 v27, v22, v23
    buffer_store_dwordx4 v[24:27], v117, s[44:47], 0 offen
L_end:
    s_endpgm
L_att_slow0:
    s_waitcnt lgkmcnt(0)
    v_mov_b32 v108, 0xff800000
    v_mov_b32 v80, 0
    v_mov_b32 v81, 0
    v_mov_b32 v82, 0
    v_mov_b32 v83, 0
    v_mov_b32 v84, 0
    v_mov_b32 v85, 0
    v_mov_b32 v86, 0
    v_mov_b32 v87, 0
    v_mov_b32 v88, 0
    v_mov_b32 v89, 0
    v_mov_b32 v90, 0
    v_mov_b32 v91, 0
    v_mov_b32 v92, 0
    v_mov_b32 v93, 0
    v_mov_b32 v94, 0
    v_mov_b32 v95, 0
    s_add_u32 s57, s18, 0xa00000
    buffer_store_dwordx4 v[128:131], v3, s[32:35], s57 offen sc1
    s_add_u32 s57, s18, 0xa00400
    buffer_store_dwordx4 v[132:135], v3, s[32:35], s57 offen sc1
    s_cmp_eq_u32 s23, 0
    s_cbranch_scc1 L_noh_18
    s_add_u32 s57, s22, 0xa00000
    buffer_store_dwordx4 v[136:139], v3, s[32:35], s57 offen sc1
L_noh_18:
    s_cmp_eq_u32 s23, 0
    s_cbranch_scc1 L_noh_19
    s_add_u32 s57, s22, 0xa00400
    buffer_store_dwordx4 v[140:143], v3, s[32:35], s57 offen sc1
L_noh_19:
    s_cmp_eq_u32 s23, 0
    s_cbranch_scc1 L_noh_20
    s_add_u32 s57, s22, 0xa00800
    buffer_store_dwordx4 v[144:147], v3, s[32:35], s57 offen sc1
L_noh_20:
    s_add_u32 m0, s26, 65536
    s_add_u32 s57, s101, 0x408000
    buffer_load_dwordx4 v3, s[32:35], s57 offen sc1 lds
    s_add_u32 m0, s26, 66560
    s_add_u32 s57, s101, 0x408400
    buffer_load_dwordx4 v3, s[32:35], s57 offen sc1 lds
    s_add_u32 m0, s26, 131072
    s_add_u32 s57, s101, 0x608000
    buffer_load_dwordx4 v3, s[32:35], s57 offen sc1 lds
    s_add_u32 m0, s26, 132096
    s_add_u32 s57, s101, 0x608400
    buffer_load_dwordx4 v3, s[32:35], s57 offen sc1 lds
    s_add_u32 m0, s26, 81920
    s_add_u32 s57, s101, 0x40c000
    buffer_load_dwordx4 v3, s[32:35], s57 offen sc1 lds
    s_add_u32 m0, s26, 82944
    s_add_u32 s57, s101, 0x40c400
    buffer_load_dwordx4 v3, s[32:35], s57 offen sc1 lds
    s_add_u32 m0, s26, 147456
    s_add_u32 s57, s101, 0x60c000
    buffer_load_dwordx4 v3, s[32:35], s57 offen sc1 lds
    s_add_u32 m0, s26, 148480
    s_add_u32 s57, s101, 0x60c400
    buffer_load_dwordx4 v3, s[32:35], s57 offen sc1 lds
    s_mov_b32 s59, 0
L_att_slow_loop21:
    ds_read_b128 v[8:11], v96
    s_mov_b64 exec, s[14:15]
    ds_read_b128 v[16:19], v97
    ds_read_b128 v[20:23], v97 offset:512
    s_mov_b64 exec, -1
    s_waitcnt lgkmcnt(0)
    v_mfma_f32_32x32x16_bf16 v[32:47], v[8:11], v[4:7], 0
    s_nop 11
    v_max3_f32 v109, v32, v33, v34
    v_max3_f32 v109, v109, v35, v36
    v_max3_f32 v109, v109, v37, v38
    v_max3_f32 v109, v109, v39, v40
    v_max3_f32 v109, v109, v41, v42
    v_max3_f32 v109, v109, v43, v44
    v_max3_f32 v109, v109, v45, v46
    v_max_f32 v109, v109, v47
    v_mov_b32 v110, v109
    s_nop 0
    s_nop 0
    v_permlane32_swap_b32 v109, v110
    v_max3_f32 v109, v109, v110, v108
    v_sub_f32 v110, v108, v109
    v_exp_f32 v110, v110
    v_mov_b32 v108, v109
    v_sub_f32 v32, v32, v109
    v_sub_f32 v33, v33, v109
    v_sub_f32 v34, v34, v109
    v_sub_f32 v35, v35, v109
    v_sub_f32 v36, v36, v109
    v_sub_f32 v37, v37, v109
    v_sub_f32 v38, v38, v109
    v_sub_f32 v39, v39, v109
    v_sub_f32 v40, v40, v109
    v_sub_f32 v41, v41, v109
    v_sub_f32 v42, v42, v109
    v_sub_f32 v43, v43, v109
    v_sub_f32 v44, v44, v109
    v_sub_f32 v45, v45, v109
    v_sub_f32 v46, v46, v109
    v_sub_f32 v47, v47, v109
    v_exp_f32 v32, v32
    v_exp_f32 v33, v33
    v_exp_f32 v34, v34
    v_exp_f32 v35, v35
    v_exp_f32 v36, v36
    v_exp_f32 v37, v37
    v_exp_f32 v38, v38
    v_exp_f32 v39, v39
    v_exp_f32 v40, v40
    v_exp_f32 v41, v41
    v_exp_f32 v42, v42
    v_exp_f32 v43, v43
    v_exp_f32 v44, v44
    v_exp_f32 v45, v45
    v_exp_f32 v46, v46
    v_exp_f32 v47, v47
    v_mul_f32 v80, v110, v80
    v_mul_f32 v81, v110, v81
    v_mul_f32 v82, v110, v82
    v_mul_f32 v83, v110, v83
    v_mul_f32 v84, v110, v84
    v_mul_f32 v85, v110, v85
    v_mul_f32 v86, v110, v86
    v_mul_f32 v87, v110, v87
    v_mul_f32 v88, v110, v88
    v_mul_f32 v89, v110, v89
    v_mul_f32 v90, v110, v90
    v_mul_f32 v91, v110, v91
    v_mul_f32 v92, v110, v92
    v_mul_f32 v93, v110, v93
    v_mul_f32 v94, v110, v94
    v_mul_f32 v95, v110, v95
    v_cvt_pk_bf16_f32 v64, v32, v33
    v_cvt_pk_bf16_f32 v65, v34, v35
    v_cvt_pk_bf16_f32 v66, v36, v37
    v_cvt_pk_bf16_f32 v67, v38, v39
    v_cvt_pk_bf16_f32 v68, v40, v41
    v_cvt_pk_bf16_f32 v69, v42, v43
    v_cvt_pk_bf16_f32 v70, v44, v45
    v_cvt_pk_bf16_f32 v71, v46, v47
    v_mfma_f32_32x32x16_bf16 v[80:95], v[16:19], v[64:67], v[80:95]
    s_nop 0
    v_mfma_f32_32x32x16_bf16 v[80:95], v[20:23], v[68:71], v[80:95]
    v_add_u32 v96, 1024, v96
    v_add_u32 v97, 1024, v97
    s_add_u32 s59, s59, 1
    s_cmp_lt_u32 s59, 16
    s_cbranch_scc1 L_att_slow_loop21
    s_waitcnt vmcnt(6)
    s_barrier
    s_add_u32 s56, s49, 16
    s_lshl_b32 s56, s56, 8
    v_mov_b32 v104, 0x7fff0000
    v_mov_b32 v105, s56
    v_cmp_eq_u32 vcc, 0, v0
    s_nop 1
    v_cndmask_b32 v104, v104, v105, vcc
    v_mov_b32 v105, 1
    buffer_atomic_add v105, v104, s[32:35], 0 offen sc1
    s_mov_b32 s44, s16
    s_mov_b32 s45, s17
    s_mov_b32 s46, 0x1c0000
    s_mov_b32 s47, 0x20000
    s_mul_i32 s56, s55, 57344
    s_mul_i32 s57, s48, 7168
    s_add_u32 s56, s56, s57
    v_lshlrev_b32 v100, 6, v2
    buffer_load_dword v103, v100, s[44:47], s56 offen
    s_add_u32 s56, s56, 3072
    buffer_load_dword v104, v100, s[44:47], s56 offen
    s_mov_b32 s44, s8
    s_mov_b32 s45, s9
    s_mov_b32 s46, 0x80000
    s_mov_b32 s47, 0x20000
    s_lshl_b32 s56, s55, 14
    s_lshl_b32 s57, s48, 11
    s_add_u32 s56, s56, s57
    v_and_b32 v106, 31, v2
    v_lshlrev_b32 v106, 6, v106
    buffer_load_dword v105, v106, s[44:47], s56 offen
    s_lshr_b32 s56, s67, 1
    s_add_u32 s56, s56, 16
    s_lshl_b32 s56, s56, 8
    v_mov_b32 v100, s56
    buffer_load_dword v101, v100, s[32:35], 0 offen sc1
    s_mov_b32 s59, 0
L_att_slow_loop22:
    ds_read_b128 v[8:11], v96
    s_mov_b64 exec, s[14:15]
    ds_read_b128 v[16:19], v97
    ds_read_b128 v[20:23], v97 offset:512
    s_mov_b64 exec, -1
    s_waitcnt lgkmcnt(0)
    v_mfma_f32_32x32x16_bf16 v[32:47], v[8:11], v[4:7], 0
    s_nop 11
    v_max3_f32 v109, v32, v33, v34
    v_max3_f32 v109, v109, v35, v36
    v_max3_f32 v109, v109, v37, v38
    v_max3_f32 v109, v109, v39, v40
    v_max3_f32 v109, v109, v41, v42
    v_max3_f32 v109, v109, v43, v44
    v_max3_f32 v109, v109, v45, v46
    v_max_f32 v109, v109, v47
    v_mov_b32 v110, v109
    s_nop 0
    s_nop 0
    v_permlane32_swap_b32 v109, v110
    v_max3_f32 v109, v109, v110, v108
    v_sub_f32 v110, v108, v109
    v_exp_f32 v110, v110
    v_mov_b32 v108, v109
    v_sub_f32 v32, v32, v109
    v_sub_f32 v33, v33, v109
    v_sub_f32 v34, v34, v109
    v_sub_f32 v35, v35, v109
    v_sub_f32 v36, v36, v109
    v_sub_f32 v37, v37, v109
    v_sub_f32 v38, v38, v109
    v_sub_f32 v39, v39, v109
    v_sub_f32 v40, v40, v109
    v_sub_f32 v41, v41, v109
    v_sub_f32 v42, v42, v109
    v_sub_f32 v43, v43, v109
    v_sub_f32 v44, v44, v109
    v_sub_f32 v45, v45, v109
    v_sub_f32 v46, v46, v109
    v_sub_f32 v47, v47, v109
    v_exp_f32 v32, v32
    v_exp_f32 v33, v33
    v_exp_f32 v34, v34
    v_exp_f32 v35, v35
    v_exp_f32 v36, v36
    v_exp_f32 v37, v37
    v_exp_f32 v38, v38
    v_exp_f32 v39, v39
    v_exp_f32 v40, v40
    v_exp_f32 v41, v41
    v_exp_f32 v42, v42
    v_exp_f32 v43, v43
    v_exp_f32 v44, v44
    v_exp_f32 v45, v45
    v_exp_f32 v46, v46
    v_exp_f32 v47, v47
    v_mul_f32 v80, v110, v80
    v_mul_f32 v81, v110, v81
    v_mul_f32 v82, v110, v82
    v_mul_f32 v83, v110, v83
    v_mul_f32 v84, v110, v84
    v_mul_f32 v85, v110, v85
    v_mul_f32 v86, v110, v86
    v_mul_f32 v87, v110, v87
    v_mul_f32 v88, v110, v88
    v_mul_f32 v89, v110, v89
    v_mul_f32 v90, v110, v90
    v_mul_f32 v91, v110, v91
    v_mul_f32 v92, v110, v92
    v_mul_f32 v93, v110, v93
    v_mul_f32 v94, v110, v94
    v_mul_f32 v95, v110, v95
    v_cvt_pk_bf16_f32 v64, v32, v33
    v_cvt_pk_bf16_f32 v65, v34, v35
    v_cvt_pk_bf16_f32 v66, v36, v37
    v_cvt_pk_bf16_f32 v67, v38, v39
    v_cvt_pk_bf16_f32 v68, v40, v41
    v_cvt_pk_bf16_f32 v69, v42, v43
    v_cvt_pk_bf16_f32 v70, v44, v45
    v_cvt_pk_bf16_f32 v71, v46, v47
    v_mfma_f32_32x32x16_bf16 v[80:95], v[16:19], v[64:67], v[80:95]
    s_nop 0
    v_mfma_f32_32x32x16_bf16 v[80:95], v[20:23], v[68:71], v[80:95]
    v_add_u32 v96, 1024, v96
    v_add_u32 v97, 1024, v97
    s_add_u32 s59, s59, 1
    s_cmp_lt_u32 s59, 16
    s_cbranch_scc1 L_att_slow_loop22
    s_waitcnt vmcnt(0)
    s_cmp_eq_u32 s48, 0
    s_cbranch_scc0 L_ok23
    v_readfirstlane_b32 s56, v101
    s_nop 0
    s_cmp_ge_u32 s56, 16
    s_cbranch_scc1 L_ok23
    s_mov_b32 s66, 0
L_poll23:
    buffer_load_dword v101, v100, s[32:35], 0 offen sc1
    s_waitcnt vmcnt(0)
    v_readfirstlane_b32 s56, v101
    s_add_u32 s66, s66, 1
    s_cmp_ge_u32 s66, 0x80000
    s_cbranch_scc1 L_ok23
    s_cmp_lt_u32 s56, 16
    s_cbranch_scc1 L_poll23
L_ok23:
    s_waitcnt lgkmcnt(0)
    s_barrier
    s_mov_b32 s36, s16
    s_mov_b32 s37, s17
    s_mov_b32 s38, 0x1c0000
    s_mov_b32 s39, 0x20000
    s_mov_b32 s28, s8
    s_mov_b32 s29, s9
    s_mov_b32 s30, 0x80000
    s_mov_b32 s31, 0x20000
    v_bfe_u32 v100, v2, 4, 1
    v_lshlrev_b32 v100, 2, v100
    v_and_b32 v101, 7, v2
    v_xor_b32 v100, v100, v101
    v_lshlrev_b32 v100, 4, v100
    s_lshl_b32 s56, s68, 7
    v_add_u32 v100, s56, v100
    v_lshrrev_b32 v101, 3, v2
    s_lshl_b32 s57, s11, 5
    v_add_u32 v101, s57, v101
    s_mul_i32 s56, s10, 448
    v_add_u32 v102, s56, v101
    v_lshl_add_u32 v112, v102, 10, v100
    s_lshl_b32 s56, s10, 7
    v_add_u32 v102, s56, v101
    v_lshl_add_u32 v113, v102, 10, v100
    s_add_u32 m0, s3, 32768
    s_mov_b32 s57, 0
    buffer_load_dwordx4 v112, s[36:39], s57 offen lds
    s_mul_i32 s24, s62, 112
    s_mul_i32 s57, s10, 28
    s_add_u32 s24, s24, s57
    s_lshl_b32 s24, s24, 10
    s_add_u32 s24, s24, 0xa00000
    buffer_load_dwordx4 v[128:131], v3, s[32:35], s24 offen sc1
    s_add_u32 m0, s3, 33792
    s_mov_b32 s57, 8192
    buffer_load_dwordx4 v112, s[36:39], s57 offen lds
    buffer_load_dwordx4 v[132:135], v3, s[32:35], s24 offen offset:1024 sc1
    s_add_u32 m0, s3, 34816
    s_mov_b32 s57, 16384
    buffer_load_dwordx4 v112, s[36:39], s57 offen lds
    buffer_load_dwordx4 v[136:139], v3, s[32:35], s24 offen offset:2048 sc1
    s_add_u32 m0, s3, 35840
    s_mov_b32 s57, 24576
    buffer_load_dwordx4 v112, s[36:39], s57 offen lds
    buffer_load_dwordx4 v[140:143], v3, s[32:35], s24 offen offset:3072 sc1
    s_add_u32 s24, s24, 4096
    s_add_u32 m0, s3, 98304
    s_mov_b32 s57, 65536
    buffer_load_dwordx4 v112, s[36:39], s57 offen lds
    buffer_load_dwordx4 v[144:147], v3, s[32:35], s24 offen sc1
    s_add_u32 m0, s3, 99328
    s_mov_b32 s57, 73728
    buffer_load_dwordx4 v112, s[36:39], s57 offen lds
    buffer_load_dwordx4 v[148:151], v3, s[32:35], s24 offen offset:1024 sc1
    s_add_u32 m0, s3, 100352
    s_mov_b32 s57, 81920
    buffer_load_dwordx4 v112, s[36:39], s57 offen lds
    buffer_load_dwordx4 v[152:155], v3, s[32:35], s24 offen offset:2048 sc1
    s_add_u32 m0, s3, 101376
    s_mov_b32 s57, 90112
    buffer_load_dwordx4 v112, s[36:39], s57 offen lds
    buffer_load_dwordx4 v[156:159], v3, s[32:35], s24 offen offset:3072 sc1
    s_add_u32 s24, s24, 4096
    s_add_u32 m0, s3, 0
    s_mov_b32 s57, 131072
    buffer_load_dwordx4 v112, s[36:39], s57 offen lds
    buffer_load_dwordx4 v[160:163], v3, s[32:35], s24 offen sc1
    s_add_u32 m0, s3, 1024
    s_mov_b32 s57, 139264
    buffer_load_dwordx4 v112, s[36:39], s57 offen lds
    buffer_load_dwordx4 v[164:167], v3, s[32:35], s24 offen offset:1024 sc1
    s_add_u32 m0, s3, 2048
    s_mov_b32 s57, 147456
    buffer_load_dwordx4 v112, s[36:39], s57 offen lds
    buffer_load_dwordx4 v[168:171], v3, s[32:35], s24 offen offset:2048 sc1
    s_add_u32 m0, s3, 3072
    s_mov_b32 s57, 155648
    buffer_load_dwordx4 v112, s[36:39], s57 offen lds
    buffer_load_dwordx4 v[172:175], v3, s[32:35], s24 offen offset:3072 sc1
    s_add_u32 s24, s24, 4096
    buffer_load_dwordx4 v[176:179], v3, s[32:35], s24 offen sc1
    buffer_load_dwordx4 v[180:183], v3, s[32:35], s24 offen offset:1024 sc1
    buffer_load_dwordx4 v[184:187], v3, s[32:35], s24 offen offset:2048 sc1
    buffer_load_dwordx4 v[188:191], v3, s[32:35], s24 offen offset:3072 sc1
    s_add_u32 s24, s24, 4096
    buffer_load_dwordx4 v[192:195], v3, s[32:35], s24 offen sc1
    buffer_load_dwordx4 v[196:199], v3, s[32:35], s24 offen offset:1024 sc1
    buffer_load_dwordx4 v[200:203], v3, s[32:35], s24 offen offset:2048 sc1
    buffer_load_dwordx4 v[204:207], v3, s[32:35], s24 offen offset:3072 sc1
    s_add_u32 s24, s24, 4096
    buffer_load_dwordx4 v[208:211], v3, s[32:35], s24 offen sc1
    buffer_load_dwordx4 v[212:215], v3, s[32:35], s24 offen offset:1024 sc1
    buffer_load_dwordx4 v[216:219], v3, s[32:35], s24 offen offset:2048 sc1
    buffer_load_dwordx4 v[220:223], v3, s[32:35], s24 offen offset:3072 sc1
    s_add_u32 s24, s24, 4096
    buffer_load_dwordx4 v[224:227], v3, s[32:35], s24 offen sc1
    buffer_load_dwordx4 v[228:231], v3, s[32:35], s24 offen offset:1024 sc1
    buffer_load_dwordx4 v[232:235], v3, s[32:35], s24 offen offset:2048 sc1
    buffer_load_dwordx4 v[236:239], v3, s[32:35], s24 offen offset:3072 sc1
    s_add_u32 s24, s24, 4096
    v_lshrrev_b32 v107, 5, v2
    v_lshlrev_b32 v107, 16, v107
    v_and_b32 v106, 31, v2
    v_lshl_add_u32 v107, v106, 2, v107
    s_lshl_b32 s25, s62, 7
    s_add_u32 s25, s25, 0x10000
    buffer_load_dword v240, v107, s[32:35], s25 offen sc1
    s_add_u32 s25, s25, 8192
    buffer_load_dword v241, v107, s[32:35], s25 offen sc1
    s_add_u32 s25, s25, 8192
    buffer_load_dword v242, v107, s[32:35], s25 offen sc1
    s_add_u32 s25, s25, 8192
    buffer_load_dword v243, v107, s[32:35], s25 offen sc1
    s_add_u32 s25, s25, 8192
    buffer_load_dword v244, v107, s[32:35], s25 offen sc1
    s_add_u32 s25, s25, 8192
    buffer_load_dword v245, v107, s[32:35], s25 offen sc1
    s_add_u32 s25, s25, 8192
    buffer_load_dword v246, v107, s[32:35], s25 offen sc1
    s_add_u32 s25, s25, 8192
    buffer_load_dword v247, v107, s[32:35], s25 offen sc1
    s_mov_b32 s59, 0
L_att_slow_loop24:
    ds_read_b128 v[8:11], v96
    s_mov_b64 exec, s[14:15]
    ds_read_b128 v[16:19], v97
    ds_read_b128 v[20:23], v97 offset:512
    s_mov_b64 exec, -1
    s_waitcnt lgkmcnt(0)
    v_mfma_f32_32x32x16_bf16 v[32:47], v[8:11], v[4:7], 0
    s_nop 11
    v_max3_f32 v109, v32, v33, v34
    v_max3_f32 v109, v109, v35, v36
    v_max3_f32 v109, v109, v37, v38
    v_max3_f32 v109, v109, v39, v40
    v_max3_f32 v109, v109, v41, v42
    v_max3_f32 v109, v109, v43, v44
    v_max3_f32 v109, v109, v45, v46
    v_max_f32 v109, v109, v47
    v_mov_b32 v110, v109
    s_nop 0
    s_nop 0
    v_permlane32_swap_b32 v109, v110
    v_max3_f32 v109, v109, v110, v108
    v_sub_f32 v110, v108, v109
    v_exp_f32 v110, v110
    v_mov_b32 v108, v109
    v_sub_f32 v32, v32, v109
    v_sub_f32 v33, v33, v109
    v_sub_f32 v34, v34, v109
    v_sub_f32 v35, v35, v109
    v_sub_f32 v36, v36, v109
    v_sub_f32 v37, v37, v109
    v_sub_f32 v38, v38, v109
    v_sub_f32 v39, v39, v109
    v_sub_f32 v40, v40, v109
    v_sub_f32 v41, v41, v109
    v_sub_f32 v42, v42, v109
    v_sub_f32 v43, v43, v109
    v_sub_f32 v44, v44, v109
    v_sub_f32 v45, v45, v109
    v_sub_f32 v46, v46, v109
    v_sub_f32 v47, v47, v109
    v_exp_f32 v32, v32
    v_exp_f32 v33, v33
    v_exp_f32 v34, v34
    v_exp_f32 v35, v35
    v_exp_f32 v36, v36
    v_exp_f32 v37, v37
    v_exp_f32 v38, v38
    v_exp_f32 v39, v39
    v_exp_f32 v40, v40
    v_exp_f32 v41, v41
    v_exp_f32 v42, v42
    v_exp_f32 v43, v43
    v_exp_f32 v44, v44
    v_exp_f32 v45, v45
    v_exp_f32 v46, v46
    v_exp_f32 v47, v47
    v_mul_f32 v80, v110, v80
    v_mul_f32 v81, v110, v81
    v_mul_f32 v82, v110, v82
    v_mul_f32 v83, v110, v83
    v_mul_f32 v84, v110, v84
    v_mul_f32 v85, v110, v85
    v_mul_f32 v86, v110, v86
    v_mul_f32 v87, v110, v87
    v_mul_f32 v88, v110, v88
    v_mul_f32 v89, v110, v89
    v_mul_f32 v90, v110, v90
    v_mul_f32 v91, v110, v91
    v_mul_f32 v92, v110, v92
    v_mul_f32 v93, v110, v93
    v_mul_f32 v94, v110, v94
    v_mul_f32 v95, v110, v95
    v_cvt_pk_bf16_f32 v64, v32, v33
    v_cvt_pk_bf16_f32 v65, v34, v35
    v_cvt_pk_bf16_f32 v66, v36, v37
    v_cvt_pk_bf16_f32 v67, v38, v39
    v_cvt_pk_bf16_f32 v68, v40, v41
    v_cvt_pk_bf16_f32 v69, v42, v43
    v_cvt_pk_bf16_f32 v70, v44, v45
    v_cvt_pk_bf16_f32 v71, v46, v47
    v_mfma_f32_32x32x16_bf16 v[80:95], v[16:19], v[64:67], v[80:95]
    s_nop 0
    v_mfma_f32_32x32x16_bf16 v[80:95], v[20:23], v[68:71], v[80:95]
    v_add_u32 v96, 1024, v96
    v_add_u32 v97, 1024, v97
    s_add_u32 s59, s59, 1
    s_cmp_lt_u32 s59, 32
    s_cbranch_scc1 L_att_slow_loop24
    s_branch L_att_fin
L_codeend:
.section .rodata,"a"
.p2align 6
.amdhsa_kernel gated_mix__mha_block__glu_gated_reglu__prompt_kernel
  .amdhsa_next_free_vgpr 256
  .amdhsa_next_free_sgpr 102
  .amdhsa_accum_offset 256
  .amdhsa_group_segment_fixed_size 0
  .amdhsa_kernarg_size 88
  .amdhsa_user_sgpr_count 2
  .amdhsa_user_sgpr_kernarg_segment_ptr 1
  .amdhsa_system_sgpr_workgroup_id_x 1
  .amdhsa_float_denorm_mode_32 3
.end_amdhsa_kernel
```
